```python
import torch

def _softmax(x, axis=-1):
    return torch.softmax(x, dim=axis)
def _gelu(x):
    return torch.nn.functional.gelu(x, approximate="tanh")
def _silu(x):
    return torch.nn.functional.silu(x)
def _sigmoid(x):
    return torch.sigmoid(x)
def _layernorm(x, axis=-1, eps=1e-5):
    m = x.mean(dim=axis, keepdim=True)
    v = x.var(dim=axis, keepdim=True, unbiased=False)
    return (x - m) / torch.sqrt(v + eps)
def _scatter_add(tgt, idx, src, axis=0):
    return tgt.clone().index_add_(axis, idx, src)
def _segment_sum(src, seg, n):
    out = torch.zeros((n,) + src.shape[1:], dtype=src.dtype)
    return out.index_add_(0, seg, src)
def _pad(x, pw):
    flat = tuple(v for pair in reversed(pw) for v in pair)
    return torch.nn.functional.pad(x, flat)

kernel_name = 'gated_mix__mha_block_cached__geglu_ffn__decode'

def setup_inputs():

    _w = (lambda a: (lambda t: t.to(torch.bfloat16) if t.is_floating_point() else t)(torch.as_tensor(a)))
    def _A_setup():
        B, Sq, D = 4, 1, 512
        H, Sk, Dh = 32, 8192, 128
        return {
            "x": _w((lambda *s: torch.randn(*s, dtype=torch.bfloat16) * 0.05)(B, Sq, D)),
            "k_cache": _w((lambda *s: torch.randn(*s, dtype=torch.bfloat16) * 6.4)(B, H, Sk, Dh)),
            "v_cache": _w((lambda *s: torch.randn(*s, dtype=torch.bfloat16) * 0.2)(B, H, Sk, Dh)),
            "wq": _w((lambda *s: torch.randn(*s, dtype=torch.bfloat16) * 6.4)(D, H * Dh) * (D ** -0.5)),
            "wo": _w((lambda *s: torch.randn(*s, dtype=torch.bfloat16) * 0.2)(H * Dh, D) * ((H * Dh) ** -0.5)),
        }
    _A_in = _A_setup()

    def _B_setup():
        B, S, D, F = 4, 1, 512, 1792
        return {
            "x": _w((lambda *s: torch.randn(*s, dtype=torch.bfloat16) * 0.05)(B, S, D)),
            "w_gate": _w((lambda *s: torch.randn(*s, dtype=torch.bfloat16) * 0.05)(D, F)),
            "w_up": _w((lambda *s: torch.randn(*s, dtype=torch.bfloat16) * 0.05)(D, F)),
            "w_down": _w((lambda *s: torch.randn(*s, dtype=torch.bfloat16) * 0.05)(F, D)),
        }
    _B_in = _B_setup()

    return {
        "A_x": _A_in["x"],
        "A_k_cache": _A_in["k_cache"],
        "A_v_cache": _A_in["v_cache"],
        "A_wq": _A_in["wq"],
        "A_wo": _A_in["wo"],
        "B_x": _B_in["x"],
        "B_w_gate": _B_in["w_gate"],
        "B_w_up": _B_in["w_up"],
        "B_w_down": _B_in["w_down"],
        "gate_w": _w((lambda *s: torch.randn(*s, dtype=torch.bfloat16) * 0.05)(512) * 16.0),
    }

def reference(A_x, A_k_cache, A_v_cache, A_wq, A_wo, B_x, B_w_gate, B_w_up, B_w_down, gate_w):
    def _A_ref(x, k_cache, v_cache, wq, wo):
        B, Sq, D = x.shape
        H, Dh = 32, 128
        q = (lambda x, *d: x.permute(*d))((x @ wq).reshape(B, Sq, H, Dh), 0, 2, 1, 3)
        scores = torch.einsum("bhqd,bhkd->bhqk", q, k_cache) * (Dh ** -0.5)
        p = _softmax(scores, axis=-1)
        o = torch.einsum("bhqk,bhkd->bhqd", p, v_cache)
        return (lambda x, *d: x.permute(*d))(o, 0, 2, 1, 3).reshape(B, Sq, H * Dh) @ wo

    def _B_ref(x, w_gate, w_up, w_down):
        return (_gelu(x @ w_gate) * (x @ w_up)) @ w_down

    x = A_x
    g = _sigmoid((x * gate_w).sum(-1, keepdims=True))
    a = _A_ref(x, A_k_cache, A_v_cache, A_wq, A_wo)
    b = _B_ref(x, B_w_gate, B_w_up, B_w_down)
    return g * a + (1 - g) * b
```

```asm
; @launch grid=(256,1,1) block=(576,1,1) lds=158208
.amdgcn_target "amdgcn-amd-amdhsa--gfx950"
.text
.globl gated_mix__mha_block_cached__geglu_ffn__decode_kernel
.p2align 8
.type gated_mix__mha_block_cached__geglu_ffn__decode_kernel,@function
gated_mix__mha_block_cached__geglu_ffn__decode_kernel:
  s_cmp_ge_u32 s2, 256
  s_cbranch_scc1 L_end
  s_load_dwordx8 s[4:11], s[0:1], 0
  s_load_dwordx2 s[12:13], s[0:1], 32
  s_load_dwordx8 s[16:23], s[0:1], 48
  s_load_dwordx4 s[24:27], s[0:1], 80
  s_load_dwordx2 s[28:29], s[0:1], 96
  v_mov_b32 v165, v0
  v_lshrrev_b32 v1, 6, v0
  v_and_b32 v0, 63, v0
  v_readfirstlane_b32 s3, v1
  s_and_b32 s35, s2, 7
  s_lshr_b32 s14, s2, 3
  s_and_b32 s32, s14, 1
  s_bfe_u32 s30, s14, 0x20001
  s_lshr_b32 s14, s14, 3
  s_lshl_b32 s35, s35, 2
  s_add_u32 s31, s35, s14
  s_lshl_b32 s33, s31, 1
  s_add_u32 s33, s33, s32
  s_lshl_b32 s34, s30, 5
  s_add_u32 s34, s34, s31
  v_and_b32 v1, 15, v0
  v_lshlrev_b32 v162, 4, v1
  v_lshrrev_b32 v163, 4, v0
  v_and_b32 v3, 1, v1
  v_cmp_eq_u32 vcc, 1, v3
  v_mov_b32 v22, 0xffff
  v_mov_b32 v23, 0xffff0000
  v_cndmask_b32 v3, v22, v23, vcc
  v_lshrrev_b32 v1, 1, v1
  v_cmp_eq_u32 vcc, 0, v1
  s_nop 1
  v_cndmask_b32 v4, 0, v3, vcc
  v_cmp_eq_u32 vcc, 1, v1
  s_nop 1
  v_cndmask_b32 v5, 0, v3, vcc
  v_cmp_eq_u32 vcc, 2, v1
  s_nop 1
  v_cndmask_b32 v6, 0, v3, vcc
  v_cmp_eq_u32 vcc, 3, v1
  s_nop 1
  v_cndmask_b32 v7, 0, v3, vcc
  s_mov_b32 s60, 0x01000100
  s_mov_b32 s61, 0x03020302
  s_mov_b32 s63, 400000
  v_mov_b32 v24, 0
  v_mov_b32 v25, 0
  v_mov_b32 v26, 0
  v_mov_b32 v27, 0
  v_mov_b32 v28, 4576
  ds_write_b128 v28, v[24:27]
  ds_write_b128 v28, v[24:27] offset:16
  s_waitcnt lgkmcnt(0)
  s_barrier
  s_cmp_eq_u32 s3, 8
  s_cbranch_scc1 L_helper
  s_lshl_b32 s35, s3, 10
  v_lshl_add_u32 v2, v0, 4, s35
  s_lshl_b32 s75, s30, 1
  s_add_u32 s75, s75, s32
  s_add_u32 s76, s75, s3
  s_and_b32 s76, s76, 7
  s_lshl_b32 s77, s32, 1
  s_lshl_b32 s35, s76, 7
  v_lshl_add_u32 v24, v163, 5, s35
  s_lshl_b32 s35, s76, 6
  v_lshl_add_u32 v25, v163, 4, s35
  v_lshlrev_b32 v25, 13, v25
  s_lshl_b32 s35, s31, 8
  v_add3_u32 v25, v25, v162, s35
  s_mul_i32 s68, s30, 16
  s_and_b32 s68, s68, 127
  s_mul_i32 s68, s68, 8192
  s_lshl_b32 s35, s34, 21
  s_lshl_b32 s14, s32, 20
  s_add_u32 s69, s35, s14
  s_mov_b32 s83, s69
  s_lshl_b32 s72, s30, 10
  s_mov_b32 s80, 0
  s_mov_b32 s81, 0
  s_and_b32 s35, s31, 3
  s_cmp_eq_u32 s35, 1
  s_cselect_b32 s35, 254, 0
  s_or_b32 s81, s81, s35
  s_or_b32 s81, s81, 256
  s_waitcnt lgkmcnt(0)
  s_mov_b32 s52, s4
  s_mov_b32 s53, s5
  s_mov_b32 s54, 4096
  s_mov_b32 s55, 0x00020000
  s_mov_b32 s48, s10
  s_mov_b32 s49, s11
  s_mov_b32 s50, 4194304
  s_mov_b32 s51, 0x00020000
  s_add_u32 s35, s77, 0
  s_and_b32 s35, s35, 3
  s_lshl_b32 s35, s35, 3
  s_add_u32 s58, s35, s72
  buffer_load_dwordx2 v[112:113], v24, s[52:55], s58 offen
  s_add_u32 s35, s77, 1
  s_and_b32 s35, s35, 3
  s_lshl_b32 s35, s35, 3
  s_add_u32 s58, s35, s72
  buffer_load_dwordx2 v[114:115], v24, s[52:55], s58 offen
  s_add_u32 s35, s77, 2
  s_and_b32 s35, s35, 3
  s_lshl_b32 s35, s35, 3
  s_add_u32 s58, s35, s72
  buffer_load_dwordx2 v[116:117], v24, s[52:55], s58 offen
  s_add_u32 s35, s77, 3
  s_and_b32 s35, s35, 3
  s_lshl_b32 s35, s35, 3
  s_add_u32 s58, s35, s72
  buffer_load_dwordx2 v[118:119], v24, s[52:55], s58 offen
  s_lshl_b32 s14, s77, 2
  s_add_u32 s35, s14, 0
  s_and_b32 s35, s35, 15
  s_lshl_b32 s58, s35, 13
  buffer_load_dwordx4 v[48:51], v25, s[48:51], s58 offen
  s_add_u32 s35, s14, 1
  s_and_b32 s35, s35, 15
  s_lshl_b32 s58, s35, 13
  buffer_load_dwordx4 v[52:55], v25, s[48:51], s58 offen
  s_add_u32 s35, s14, 2
  s_and_b32 s35, s35, 15
  s_lshl_b32 s58, s35, 13
  buffer_load_dwordx4 v[56:59], v25, s[48:51], s58 offen
  s_add_u32 s35, s14, 3
  s_and_b32 s35, s35, 15
  s_lshl_b32 s58, s35, 13
  buffer_load_dwordx4 v[60:63], v25, s[48:51], s58 offen
  s_add_u32 s35, s14, 4
  s_and_b32 s35, s35, 15
  s_lshl_b32 s58, s35, 13
  buffer_load_dwordx4 v[64:67], v25, s[48:51], s58 offen
  s_add_u32 s35, s14, 5
  s_and_b32 s35, s35, 15
  s_lshl_b32 s58, s35, 13
  buffer_load_dwordx4 v[68:71], v25, s[48:51], s58 offen
  s_add_u32 s35, s14, 6
  s_and_b32 s35, s35, 15
  s_lshl_b32 s58, s35, 13
  buffer_load_dwordx4 v[72:75], v25, s[48:51], s58 offen
  s_add_u32 s35, s14, 7
  s_and_b32 s35, s35, 15
  s_lshl_b32 s58, s35, 13
  buffer_load_dwordx4 v[76:79], v25, s[48:51], s58 offen
  s_add_u32 s35, s14, 8
  s_and_b32 s35, s35, 15
  s_lshl_b32 s58, s35, 13
  buffer_load_dwordx4 v[80:83], v25, s[48:51], s58 offen
  s_add_u32 s35, s14, 9
  s_and_b32 s35, s35, 15
  s_lshl_b32 s58, s35, 13
  buffer_load_dwordx4 v[84:87], v25, s[48:51], s58 offen
  s_add_u32 s35, s14, 10
  s_and_b32 s35, s35, 15
  s_lshl_b32 s58, s35, 13
  buffer_load_dwordx4 v[88:91], v25, s[48:51], s58 offen
  s_add_u32 s35, s14, 11
  s_and_b32 s35, s35, 15
  s_lshl_b32 s58, s35, 13
  buffer_load_dwordx4 v[92:95], v25, s[48:51], s58 offen
  s_add_u32 s35, s14, 12
  s_and_b32 s35, s35, 15
  s_lshl_b32 s58, s35, 13
  buffer_load_dwordx4 v[96:99], v25, s[48:51], s58 offen
  s_add_u32 s35, s14, 13
  s_and_b32 s35, s35, 15
  s_lshl_b32 s58, s35, 13
  buffer_load_dwordx4 v[100:103], v25, s[48:51], s58 offen
  s_add_u32 s35, s14, 14
  s_and_b32 s35, s35, 15
  s_lshl_b32 s58, s35, 13
  buffer_load_dwordx4 v[104:107], v25, s[48:51], s58 offen
  s_add_u32 s35, s14, 15
  s_and_b32 s35, s35, 15
  s_lshl_b32 s58, s35, 13
  buffer_load_dwordx4 v[108:111], v25, s[48:51], s58 offen
  s_add_u32 s36, s6, s69
  s_addc_u32 s37, s7, 0
  s_mov_b32 s38, 1048576
  s_mov_b32 s39, 0x00020000
  s_add_u32 s40, s8, s83
  s_addc_u32 s41, s9, 0
  s_mov_b32 s42, 1048576
  s_mov_b32 s43, 0x00020000
  s_mov_b32 s44, s36
  s_mov_b32 s45, s37
  s_mov_b32 s46, 1048576
  s_mov_b32 s47, 0x00020000
  s_lshl_b32 s35, s3, 14
  s_add_u32 s74, s35, 27136
  s_waitcnt vmcnt(16)
  v_perm_b32 v22, v112, v112, s60
  v_and_b32 v16, v22, v4
  v_and_b32 v17, v22, v5
  v_and_b32 v18, v22, v6
  v_and_b32 v19, v22, v7
  s_waitcnt vmcnt(15)
  s_nop 0
  v_mfma_f32_16x16x32_bf16 v[120:123], v[16:19], v[48:51], 0
  v_perm_b32 v22, v112, v112, s61
  v_and_b32 v16, v22, v4
  v_and_b32 v17, v22, v5
  v_and_b32 v18, v22, v6
  v_and_b32 v19, v22, v7
  s_waitcnt vmcnt(14)
  s_nop 0
  v_mfma_f32_16x16x32_bf16 v[120:123], v[16:19], v[52:55], v[120:123]
  v_perm_b32 v22, v113, v113, s60
  v_and_b32 v16, v22, v4
  v_and_b32 v17, v22, v5
  v_and_b32 v18, v22, v6
  v_and_b32 v19, v22, v7
  s_waitcnt vmcnt(13)
  s_nop 0
  v_mfma_f32_16x16x32_bf16 v[120:123], v[16:19], v[56:59], v[120:123]
  v_perm_b32 v22, v113, v113, s61
  v_and_b32 v16, v22, v4
  v_and_b32 v17, v22, v5
  v_and_b32 v18, v22, v6
  v_and_b32 v19, v22, v7
  s_waitcnt vmcnt(12)
  s_nop 0
  v_mfma_f32_16x16x32_bf16 v[120:123], v[16:19], v[60:63], v[120:123]
  v_perm_b32 v22, v114, v114, s60
  v_and_b32 v16, v22, v4
  v_and_b32 v17, v22, v5
  v_and_b32 v18, v22, v6
  v_and_b32 v19, v22, v7
  s_waitcnt vmcnt(11)
  s_nop 0
  v_mfma_f32_16x16x32_bf16 v[120:123], v[16:19], v[64:67], v[120:123]
  v_perm_b32 v22, v114, v114, s61
  v_and_b32 v16, v22, v4
  v_and_b32 v17, v22, v5
  v_and_b32 v18, v22, v6
  v_and_b32 v19, v22, v7
  s_waitcnt vmcnt(10)
  s_nop 0
  v_mfma_f32_16x16x32_bf16 v[120:123], v[16:19], v[68:71], v[120:123]
  v_perm_b32 v22, v115, v115, s60
  v_and_b32 v16, v22, v4
  v_and_b32 v17, v22, v5
  v_and_b32 v18, v22, v6
  v_and_b32 v19, v22, v7
  s_waitcnt vmcnt(9)
  s_nop 0
  v_mfma_f32_16x16x32_bf16 v[120:123], v[16:19], v[72:75], v[120:123]
  v_perm_b32 v22, v115, v115, s61
  v_and_b32 v16, v22, v4
  v_and_b32 v17, v22, v5
  v_and_b32 v18, v22, v6
  v_and_b32 v19, v22, v7
  s_waitcnt vmcnt(8)
  s_nop 0
  v_mfma_f32_16x16x32_bf16 v[120:123], v[16:19], v[76:79], v[120:123]
  v_perm_b32 v22, v116, v116, s60
  v_and_b32 v16, v22, v4
  v_and_b32 v17, v22, v5
  v_and_b32 v18, v22, v6
  v_and_b32 v19, v22, v7
  s_waitcnt vmcnt(7)
  s_nop 0
  v_mfma_f32_16x16x32_bf16 v[120:123], v[16:19], v[80:83], v[120:123]
  v_perm_b32 v22, v116, v116, s61
  v_and_b32 v16, v22, v4
  v_and_b32 v17, v22, v5
  v_and_b32 v18, v22, v6
  v_and_b32 v19, v22, v7
  s_waitcnt vmcnt(6)
  s_nop 0
  v_mfma_f32_16x16x32_bf16 v[120:123], v[16:19], v[84:87], v[120:123]
  v_perm_b32 v22, v117, v117, s60
  v_and_b32 v16, v22, v4
  v_and_b32 v17, v22, v5
  v_and_b32 v18, v22, v6
  v_and_b32 v19, v22, v7
  s_waitcnt vmcnt(5)
  s_nop 0
  v_mfma_f32_16x16x32_bf16 v[120:123], v[16:19], v[88:91], v[120:123]
  v_perm_b32 v22, v117, v117, s61
  v_and_b32 v16, v22, v4
  v_and_b32 v17, v22, v5
  v_and_b32 v18, v22, v6
  v_and_b32 v19, v22, v7
  s_waitcnt vmcnt(4)
  s_nop 0
  v_mfma_f32_16x16x32_bf16 v[120:123], v[16:19], v[92:95], v[120:123]
  v_perm_b32 v22, v118, v118, s60
  v_and_b32 v16, v22, v4
  v_and_b32 v17, v22, v5
  v_and_b32 v18, v22, v6
  v_and_b32 v19, v22, v7
  s_waitcnt vmcnt(3)
  s_nop 0
  v_mfma_f32_16x16x32_bf16 v[120:123], v[16:19], v[96:99], v[120:123]
  v_perm_b32 v22, v118, v118, s61
  v_and_b32 v16, v22, v4
  v_and_b32 v17, v22, v5
  v_and_b32 v18, v22, v6
  v_and_b32 v19, v22, v7
  s_waitcnt vmcnt(2)
  s_nop 0
  v_mfma_f32_16x16x32_bf16 v[120:123], v[16:19], v[100:103], v[120:123]
  v_perm_b32 v22, v119, v119, s60
  v_and_b32 v16, v22, v4
  v_and_b32 v17, v22, v5
  v_and_b32 v18, v22, v6
  v_and_b32 v19, v22, v7
  s_waitcnt vmcnt(1)
  s_nop 0
  v_mfma_f32_16x16x32_bf16 v[120:123], v[16:19], v[104:107], v[120:123]
  v_perm_b32 v22, v119, v119, s61
  v_and_b32 v16, v22, v4
  v_and_b32 v17, v22, v5
  v_and_b32 v18, v22, v6
  v_and_b32 v19, v22, v7
  s_waitcnt vmcnt(0)
  s_nop 0
  v_mfma_f32_16x16x32_bf16 v[120:123], v[16:19], v[108:111], v[120:123]
  v_and_b32 v26, 15, v0
  v_lshlrev_b32 v26, 5, v26
  v_lshl_add_u32 v26, v163, 4, v26
  s_lshl_b32 s35, s3, 9
  v_add_u32 v166, s35, v26
  s_nop 3
  v_cmp_gt_u32 vcc, 32, v0
  s_and_saveexec_b64 s[70:71], vcc
  ds_write_b128 v166, v[120:123] offset:0
  s_mov_b64 exec, s[70:71]
  v_mov_b32 v26, 0
  v_mov_b32 v27, 1
  v_cmp_eq_u32 vcc, 0, v0
  s_and_saveexec_b64 s[70:71], vcc
  ds_add_u32 v26, v27 offset:4592
  s_mov_b64 exec, s[70:71]
  s_cmp_gt_u32 s3, 1
  s_cbranch_scc1 L_st2_done
  v_mov_b32 v26, 0
L_qa:
  ds_read_b32 v27, v26 offset:4592
  s_waitcnt lgkmcnt(0)
  v_readfirstlane_b32 s35, v27
  s_cmp_eq_u32 s35, 8
  s_cbranch_scc1 L_qa_ok
  s_sleep 1
  s_sub_u32 s63, s63, 1
  s_cmp_gt_i32 s63, 0
  s_cbranch_scc1 L_qa
L_qa_ok:
  v_lshlrev_b32 v26, 2, v165
  ds_read_b32 v124, v26 offset:0
  ds_read_b32 v125, v26 offset:512
  ds_read_b32 v126, v26 offset:1024
  ds_read_b32 v127, v26 offset:1536
  ds_read_b32 v128, v26 offset:2048
  ds_read_b32 v129, v26 offset:2560
  ds_read_b32 v130, v26 offset:3072
  ds_read_b32 v131, v26 offset:3584
  s_waitcnt lgkmcnt(0)
  v_add_f32 v124, v124, v125
  v_add_f32 v124, v124, v126
  v_add_f32 v124, v124, v127
  v_add_f32 v124, v124, v128
  v_add_f32 v124, v124, v129
  v_add_f32 v124, v124, v130
  v_add_f32 v124, v124, v131
  v_cvt_pk_bf16_f32 v124, v124, v124
  v_lshlrev_b32 v26, 1, v165
  ds_write_b16 v26, v124 offset:4096
  v_mov_b32 v26, 0
  v_mov_b32 v27, 1
  v_cmp_eq_u32 vcc, 0, v0
  s_and_saveexec_b64 s[70:71], vcc
  ds_add_u32 v26, v27 offset:4596
  s_mov_b64 exec, s[70:71]
L_st2_done:
  v_mov_b32 v26, 0
L_qb:
  ds_read_b32 v27, v26 offset:4596
  s_waitcnt lgkmcnt(0)
  v_readfirstlane_b32 s35, v27
  s_cmp_eq_u32 s35, 2
  s_cbranch_scc1 L_qb_ok
  s_sleep 1
  s_sub_u32 s63, s63, 1
  s_cmp_gt_i32 s63, 0
  s_cbranch_scc1 L_qb
L_qb_ok:
  ds_read_b128 v[8:11], v162 offset:4096
  v_mov_b32 v21, 0xff800000
  s_lshl_b32 s35, s3, 11
  v_lshl_add_u32 v164, v0, 2, s35
  s_add_u32 s56, s68, 131072
  s_mov_b32 s59, 1
  s_mov_b32 s62, 0x3e0293ee
  v_lshl_add_u32 v24, v0, 4, s74
  s_waitcnt lgkmcnt(0)
  s_mov_b32 s64, 0x00010001
  s_mov_b32 s65, 0x00010001
  v_mov_b32 v26, 0
L_pr0:
  ds_read_b32 v27, v26 offset:4588
  s_waitcnt lgkmcnt(0)
  v_readfirstlane_b32 s35, v27
  s_cmp_ge_u32 s35, 2
  s_cbranch_scc1 L_pr0_ok
  s_sleep 1
  s_sub_u32 s63, s63, 1
  s_cmp_gt_i32 s63, 0
  s_cbranch_scc1 L_pr0
L_pr0_ok:
  ds_read_b128 v[124:127], v24 offset:0
  ds_read_b128 v[128:131], v24 offset:1024
  v_mov_b32 v26, 0
L_pr1:
  ds_read_b32 v27, v26 offset:4588
  s_waitcnt lgkmcnt(0)
  v_readfirstlane_b32 s35, v27
  s_cmp_ge_u32 s35, 4
  s_cbranch_scc1 L_pr1_ok
  s_sleep 1
  s_sub_u32 s63, s63, 1
  s_cmp_gt_i32 s63, 0
  s_cbranch_scc1 L_pr1
L_pr1_ok:
  ds_read_b128 v[140:143], v24 offset:2048
  ds_read_b128 v[144:147], v24 offset:3072
  s_waitcnt lgkmcnt(2)
  v_dot2_f32_bf16 v22, v124, v8, 0
  v_dot2_f32_bf16 v22, v125, v9, v22
  v_dot2_f32_bf16 v22, v126, v10, v22
  v_dot2_f32_bf16 v22, v127, v11, v22
  s_nop 2
  v_add_f32_dpp v22, v22, v22 row_ror:8 row_mask:0xf bank_mask:0xf
  s_nop 1
  v_add_f32_dpp v22, v22, v22 row_ror:4 row_mask:0xf bank_mask:0xf
  s_nop 1
  v_add_f32_dpp v22, v22, v22 row_ror:2 row_mask:0xf bank_mask:0xf
  s_nop 1
  v_add_f32_dpp v22, v22, v22 row_ror:1 row_mask:0xf bank_mask:0xf
  v_cndmask_b32_e64 v20, v20, v22, s[64:65]
  s_lshl_b64 s[64:65], s[64:65], 1
  v_dot2_f32_bf16 v22, v128, v8, 0
  v_dot2_f32_bf16 v22, v129, v9, v22
  v_dot2_f32_bf16 v22, v130, v10, v22
  v_dot2_f32_bf16 v22, v131, v11, v22
  s_nop 2
  v_add_f32_dpp v22, v22, v22 row_ror:8 row_mask:0xf bank_mask:0xf
  s_nop 1
  v_add_f32_dpp v22, v22, v22 row_ror:4 row_mask:0xf bank_mask:0xf
  s_nop 1
  v_add_f32_dpp v22, v22, v22 row_ror:2 row_mask:0xf bank_mask:0xf
  s_nop 1
  v_add_f32_dpp v22, v22, v22 row_ror:1 row_mask:0xf bank_mask:0xf
  v_cndmask_b32_e64 v20, v20, v22, s[64:65]
  s_lshl_b64 s[64:65], s[64:65], 1
  v_mov_b32 v26, 0
L_pr2:
  ds_read_b32 v27, v26 offset:4588
  s_waitcnt lgkmcnt(0)
  v_readfirstlane_b32 s35, v27
  s_cmp_ge_u32 s35, 6
  s_cbranch_scc1 L_pr2_ok
  s_sleep 1
  s_sub_u32 s63, s63, 1
  s_cmp_gt_i32 s63, 0
  s_cbranch_scc1 L_pr2
L_pr2_ok:
  ds_read_b128 v[124:127], v24 offset:4096
  ds_read_b128 v[128:131], v24 offset:5120
  s_waitcnt lgkmcnt(2)
  v_dot2_f32_bf16 v22, v140, v8, 0
  v_dot2_f32_bf16 v22, v141, v9, v22
  v_dot2_f32_bf16 v22, v142, v10, v22
  v_dot2_f32_bf16 v22, v143, v11, v22
  s_nop 2
  v_add_f32_dpp v22, v22, v22 row_ror:8 row_mask:0xf bank_mask:0xf
  s_nop 1
  v_add_f32_dpp v22, v22, v22 row_ror:4 row_mask:0xf bank_mask:0xf
  s_nop 1
  v_add_f32_dpp v22, v22, v22 row_ror:2 row_mask:0xf bank_mask:0xf
  s_nop 1
  v_add_f32_dpp v22, v22, v22 row_ror:1 row_mask:0xf bank_mask:0xf
  v_cndmask_b32_e64 v20, v20, v22, s[64:65]
  s_lshl_b64 s[64:65], s[64:65], 1
  v_dot2_f32_bf16 v22, v144, v8, 0
  v_dot2_f32_bf16 v22, v145, v9, v22
  v_dot2_f32_bf16 v22, v146, v10, v22
  v_dot2_f32_bf16 v22, v147, v11, v22
  s_nop 2
  v_add_f32_dpp v22, v22, v22 row_ror:8 row_mask:0xf bank_mask:0xf
  s_nop 1
  v_add_f32_dpp v22, v22, v22 row_ror:4 row_mask:0xf bank_mask:0xf
  s_nop 1
  v_add_f32_dpp v22, v22, v22 row_ror:2 row_mask:0xf bank_mask:0xf
  s_nop 1
  v_add_f32_dpp v22, v22, v22 row_ror:1 row_mask:0xf bank_mask:0xf
  v_cndmask_b32_e64 v20, v20, v22, s[64:65]
  s_lshl_b64 s[64:65], s[64:65], 1
  v_mov_b32 v26, 0
L_pr3:
  ds_read_b32 v27, v26 offset:4588
  s_waitcnt lgkmcnt(0)
  v_readfirstlane_b32 s35, v27
  s_cmp_ge_u32 s35, 8
  s_cbranch_scc1 L_pr3_ok
  s_sleep 1
  s_sub_u32 s63, s63, 1
  s_cmp_gt_i32 s63, 0
  s_cbranch_scc1 L_pr3
L_pr3_ok:
  ds_read_b128 v[140:143], v24 offset:6144
  ds_read_b128 v[144:147], v24 offset:7168
  s_waitcnt lgkmcnt(2)
  v_dot2_f32_bf16 v22, v124, v8, 0
  v_dot2_f32_bf16 v22, v125, v9, v22
  v_dot2_f32_bf16 v22, v126, v10, v22
  v_dot2_f32_bf16 v22, v127, v11, v22
  s_nop 2
  v_add_f32_dpp v22, v22, v22 row_ror:8 row_mask:0xf bank_mask:0xf
  s_nop 1
  v_add_f32_dpp v22, v22, v22 row_ror:4 row_mask:0xf bank_mask:0xf
  s_nop 1
  v_add_f32_dpp v22, v22, v22 row_ror:2 row_mask:0xf bank_mask:0xf
  s_nop 1
  v_add_f32_dpp v22, v22, v22 row_ror:1 row_mask:0xf bank_mask:0xf
  v_cndmask_b32_e64 v20, v20, v22, s[64:65]
  s_lshl_b64 s[64:65], s[64:65], 1
  v_dot2_f32_bf16 v22, v128, v8, 0
  v_dot2_f32_bf16 v22, v129, v9, v22
  v_dot2_f32_bf16 v22, v130, v10, v22
  v_dot2_f32_bf16 v22, v131, v11, v22
  s_nop 2
  v_add_f32_dpp v22, v22, v22 row_ror:8 row_mask:0xf bank_mask:0xf
  s_nop 1
  v_add_f32_dpp v22, v22, v22 row_ror:4 row_mask:0xf bank_mask:0xf
  s_nop 1
  v_add_f32_dpp v22, v22, v22 row_ror:2 row_mask:0xf bank_mask:0xf
  s_nop 1
  v_add_f32_dpp v22, v22, v22 row_ror:1 row_mask:0xf bank_mask:0xf
  v_cndmask_b32_e64 v20, v20, v22, s[64:65]
  s_lshl_b64 s[64:65], s[64:65], 1
  v_mov_b32 v26, 0
L_pr4:
  ds_read_b32 v27, v26 offset:4588
  s_waitcnt lgkmcnt(0)
  v_readfirstlane_b32 s35, v27
  s_cmp_ge_u32 s35, 10
  s_cbranch_scc1 L_pr4_ok
  s_sleep 1
  s_sub_u32 s63, s63, 1
  s_cmp_gt_i32 s63, 0
  s_cbranch_scc1 L_pr4
L_pr4_ok:
  ds_read_b128 v[124:127], v24 offset:8192
  ds_read_b128 v[128:131], v24 offset:9216
  s_waitcnt lgkmcnt(2)
  v_dot2_f32_bf16 v22, v140, v8, 0
  v_dot2_f32_bf16 v22, v141, v9, v22
  v_dot2_f32_bf16 v22, v142, v10, v22
  v_dot2_f32_bf16 v22, v143, v11, v22
  s_nop 2
  v_add_f32_dpp v22, v22, v22 row_ror:8 row_mask:0xf bank_mask:0xf
  s_nop 1
  v_add_f32_dpp v22, v22, v22 row_ror:4 row_mask:0xf bank_mask:0xf
  s_nop 1
  v_add_f32_dpp v22, v22, v22 row_ror:2 row_mask:0xf bank_mask:0xf
  s_nop 1
  v_add_f32_dpp v22, v22, v22 row_ror:1 row_mask:0xf bank_mask:0xf
  v_cndmask_b32_e64 v20, v20, v22, s[64:65]
  s_lshl_b64 s[64:65], s[64:65], 1
  v_dot2_f32_bf16 v22, v144, v8, 0
  v_dot2_f32_bf16 v22, v145, v9, v22
  v_dot2_f32_bf16 v22, v146, v10, v22
  v_dot2_f32_bf16 v22, v147, v11, v22
  s_nop 2
  v_add_f32_dpp v22, v22, v22 row_ror:8 row_mask:0xf bank_mask:0xf
  s_nop 1
  v_add_f32_dpp v22, v22, v22 row_ror:4 row_mask:0xf bank_mask:0xf
  s_nop 1
  v_add_f32_dpp v22, v22, v22 row_ror:2 row_mask:0xf bank_mask:0xf
  s_nop 1
  v_add_f32_dpp v22, v22, v22 row_ror:1 row_mask:0xf bank_mask:0xf
  v_cndmask_b32_e64 v20, v20, v22, s[64:65]
  s_lshl_b64 s[64:65], s[64:65], 1
  v_mov_b32 v26, 0
L_pr5:
  ds_read_b32 v27, v26 offset:4588
  s_waitcnt lgkmcnt(0)
  v_readfirstlane_b32 s35, v27
  s_cmp_ge_u32 s35, 12
  s_cbranch_scc1 L_pr5_ok
  s_sleep 1
  s_sub_u32 s63, s63, 1
  s_cmp_gt_i32 s63, 0
  s_cbranch_scc1 L_pr5
L_pr5_ok:
  ds_read_b128 v[140:143], v24 offset:10240
  ds_read_b128 v[144:147], v24 offset:11264
  s_add_u32 s58, s68, 131072
  s_and_b32 s58, s58, 1048575
  buffer_load_dwordx4 v[32:35], v2, s[36:39], s58 offen nt
  s_waitcnt lgkmcnt(2)
  v_dot2_f32_bf16 v22, v124, v8, 0
  v_dot2_f32_bf16 v22, v125, v9, v22
  v_dot2_f32_bf16 v22, v126, v10, v22
  v_dot2_f32_bf16 v22, v127, v11, v22
  s_nop 2
  v_add_f32_dpp v22, v22, v22 row_ror:8 row_mask:0xf bank_mask:0xf
  s_nop 1
  v_add_f32_dpp v22, v22, v22 row_ror:4 row_mask:0xf bank_mask:0xf
  s_nop 1
  v_add_f32_dpp v22, v22, v22 row_ror:2 row_mask:0xf bank_mask:0xf
  s_nop 1
  v_add_f32_dpp v22, v22, v22 row_ror:1 row_mask:0xf bank_mask:0xf
  v_cndmask_b32_e64 v20, v20, v22, s[64:65]
  s_lshl_b64 s[64:65], s[64:65], 1
  v_dot2_f32_bf16 v22, v128, v8, 0
  v_dot2_f32_bf16 v22, v129, v9, v22
  v_dot2_f32_bf16 v22, v130, v10, v22
  v_dot2_f32_bf16 v22, v131, v11, v22
  s_nop 2
  v_add_f32_dpp v22, v22, v22 row_ror:8 row_mask:0xf bank_mask:0xf
  s_nop 1
  v_add_f32_dpp v22, v22, v22 row_ror:4 row_mask:0xf bank_mask:0xf
  s_nop 1
  v_add_f32_dpp v22, v22, v22 row_ror:2 row_mask:0xf bank_mask:0xf
  s_nop 1
  v_add_f32_dpp v22, v22, v22 row_ror:1 row_mask:0xf bank_mask:0xf
  v_cndmask_b32_e64 v20, v20, v22, s[64:65]
  s_lshl_b64 s[64:65], s[64:65], 1
  v_mov_b32 v26, 0
L_pr6:
  ds_read_b32 v27, v26 offset:4588
  s_waitcnt lgkmcnt(0)
  v_readfirstlane_b32 s35, v27
  s_cmp_ge_u32 s35, 14
  s_cbranch_scc1 L_pr6_ok
  s_sleep 1
  s_sub_u32 s63, s63, 1
  s_cmp_gt_i32 s63, 0
  s_cbranch_scc1 L_pr6
L_pr6_ok:
  ds_read_b128 v[124:127], v24 offset:12288
  ds_read_b128 v[128:131], v24 offset:13312
  s_add_u32 s58, s68, 139264
  s_and_b32 s58, s58, 1048575
  buffer_load_dwordx4 v[36:39], v2, s[36:39], s58 offen nt
  s_add_u32 s58, s68, 147456
  s_and_b32 s58, s58, 1048575
  buffer_load_dwordx4 v[40:43], v2, s[36:39], s58 offen nt
  s_waitcnt lgkmcnt(2)
  v_dot2_f32_bf16 v22, v140, v8, 0
  v_dot2_f32_bf16 v22, v141, v9, v22
  v_dot2_f32_bf16 v22, v142, v10, v22
  v_dot2_f32_bf16 v22, v143, v11, v22
  s_nop 2
  v_add_f32_dpp v22, v22, v22 row_ror:8 row_mask:0xf bank_mask:0xf
  s_nop 1
  v_add_f32_dpp v22, v22, v22 row_ror:4 row_mask:0xf bank_mask:0xf
  s_nop 1
  v_add_f32_dpp v22, v22, v22 row_ror:2 row_mask:0xf bank_mask:0xf
  s_nop 1
  v_add_f32_dpp v22, v22, v22 row_ror:1 row_mask:0xf bank_mask:0xf
  v_cndmask_b32_e64 v20, v20, v22, s[64:65]
  s_lshl_b64 s[64:65], s[64:65], 1
  v_dot2_f32_bf16 v22, v144, v8, 0
  v_dot2_f32_bf16 v22, v145, v9, v22
  v_dot2_f32_bf16 v22, v146, v10, v22
  v_dot2_f32_bf16 v22, v147, v11, v22
  s_nop 2
  v_add_f32_dpp v22, v22, v22 row_ror:8 row_mask:0xf bank_mask:0xf
  s_nop 1
  v_add_f32_dpp v22, v22, v22 row_ror:4 row_mask:0xf bank_mask:0xf
  s_nop 1
  v_add_f32_dpp v22, v22, v22 row_ror:2 row_mask:0xf bank_mask:0xf
  s_nop 1
  v_add_f32_dpp v22, v22, v22 row_ror:1 row_mask:0xf bank_mask:0xf
  v_cndmask_b32_e64 v20, v20, v22, s[64:65]
  s_lshl_b64 s[64:65], s[64:65], 1
  v_mov_b32 v26, 0
L_pr7:
  ds_read_b32 v27, v26 offset:4588
  s_waitcnt lgkmcnt(0)
  v_readfirstlane_b32 s35, v27
  s_cmp_ge_u32 s35, 16
  s_cbranch_scc1 L_pr7_ok
  s_sleep 1
  s_sub_u32 s63, s63, 1
  s_cmp_gt_i32 s63, 0
  s_cbranch_scc1 L_pr7
L_pr7_ok:
  ds_read_b128 v[140:143], v24 offset:14336
  ds_read_b128 v[144:147], v24 offset:15360
  s_waitcnt lgkmcnt(2)
  v_dot2_f32_bf16 v22, v124, v8, 0
  v_dot2_f32_bf16 v22, v125, v9, v22
  v_dot2_f32_bf16 v22, v126, v10, v22
  v_dot2_f32_bf16 v22, v127, v11, v22
  s_nop 2
  v_add_f32_dpp v22, v22, v22 row_ror:8 row_mask:0xf bank_mask:0xf
  s_nop 1
  v_add_f32_dpp v22, v22, v22 row_ror:4 row_mask:0xf bank_mask:0xf
  s_nop 1
  v_add_f32_dpp v22, v22, v22 row_ror:2 row_mask:0xf bank_mask:0xf
  s_nop 1
  v_add_f32_dpp v22, v22, v22 row_ror:1 row_mask:0xf bank_mask:0xf
  v_cndmask_b32_e64 v20, v20, v22, s[64:65]
  s_lshl_b64 s[64:65], s[64:65], 1
  v_dot2_f32_bf16 v22, v128, v8, 0
  v_dot2_f32_bf16 v22, v129, v9, v22
  v_dot2_f32_bf16 v22, v130, v10, v22
  v_dot2_f32_bf16 v22, v131, v11, v22
  s_nop 2
  v_add_f32_dpp v22, v22, v22 row_ror:8 row_mask:0xf bank_mask:0xf
  s_nop 1
  v_add_f32_dpp v22, v22, v22 row_ror:4 row_mask:0xf bank_mask:0xf
  s_nop 1
  v_add_f32_dpp v22, v22, v22 row_ror:2 row_mask:0xf bank_mask:0xf
  s_nop 1
  v_add_f32_dpp v22, v22, v22 row_ror:1 row_mask:0xf bank_mask:0xf
  v_cndmask_b32_e64 v20, v20, v22, s[64:65]
  s_lshl_b64 s[64:65], s[64:65], 1
  s_waitcnt lgkmcnt(0)
  v_mov_b32 v26, 0
  v_mov_b32 v27, 1
  v_cmp_eq_u32 vcc, 0, v0
  s_and_saveexec_b64 s[70:71], vcc
  ds_add_u32 v26, v27 offset:4584
  s_mov_b64 exec, s[70:71]
  v_dot2_f32_bf16 v22, v140, v8, 0
  v_dot2_f32_bf16 v22, v141, v9, v22
  v_dot2_f32_bf16 v22, v142, v10, v22
  v_dot2_f32_bf16 v22, v143, v11, v22
  s_nop 2
  v_add_f32_dpp v22, v22, v22 row_ror:8 row_mask:0xf bank_mask:0xf
  s_nop 1
  v_add_f32_dpp v22, v22, v22 row_ror:4 row_mask:0xf bank_mask:0xf
  s_nop 1
  v_add_f32_dpp v22, v22, v22 row_ror:2 row_mask:0xf bank_mask:0xf
  s_nop 1
  v_add_f32_dpp v22, v22, v22 row_ror:1 row_mask:0xf bank_mask:0xf
  v_cndmask_b32_e64 v20, v20, v22, s[64:65]
  s_lshl_b64 s[64:65], s[64:65], 1
  v_dot2_f32_bf16 v22, v144, v8, 0
  v_dot2_f32_bf16 v22, v145, v9, v22
  v_dot2_f32_bf16 v22, v146, v10, v22
  v_dot2_f32_bf16 v22, v147, v11, v22
  s_nop 2
  v_add_f32_dpp v22, v22, v22 row_ror:8 row_mask:0xf bank_mask:0xf
  s_nop 1
  v_add_f32_dpp v22, v22, v22 row_ror:4 row_mask:0xf bank_mask:0xf
  s_nop 1
  v_add_f32_dpp v22, v22, v22 row_ror:2 row_mask:0xf bank_mask:0xf
  s_nop 1
  v_add_f32_dpp v22, v22, v22 row_ror:1 row_mask:0xf bank_mask:0xf
  v_cndmask_b32_e64 v20, v20, v22, s[64:65]
  s_lshl_b64 s[64:65], s[64:65], 1
  v_mul_f32 v20, s62, v20
  v_max_f32 v21, v21, v20
  ds_write_b32 v164, v20 offset:10752
  v_add_u32 v164, 256, v164
L_kloop:
  s_add_u32 s57, s56, 131072
  s_cmp_lg_u32 s59, 7
  s_cbranch_scc1 L_kbody
  s_mov_b32 s44, s40
  s_mov_b32 s45, s41
  s_mov_b32 s57, s68
L_kbody:
  s_mov_b32 s64, 0x00010001
  s_mov_b32 s65, 0x00010001
  v_mov_b32 v28, 0
  ds_read_b32 v29, v28 offset:4600
  s_waitcnt lgkmcnt(0)
  v_readfirstlane_b32 s79, v29
  s_add_u32 s35, s59, 0
  s_lshr_b32 s35, s81, s35
  s_and_b32 s35, s35, 1
  s_or_b32 s79, s79, s35
  s_mov_b32 s82, 0
  s_cmp_eq_u32 s79, s80
  s_cbranch_scc1 L_k_same
  s_cmp_eq_u32 s79, 0
  s_cbranch_scc1 L_k_down
  s_add_u32 s58, s56, 24576
  s_and_b32 s58, s58, 1048575
  buffer_load_dwordx4 v[44:47], v2, s[36:39], s58 offen nt
  s_branch L_k_same
L_k_down:
  s_mov_b32 s82, 1
L_k_same:
  s_mov_b32 s80, s79
  s_cmp_eq_u32 s79, 1
  s_cbranch_scc1 L_k_hi
  s_waitcnt vmcnt(2)
  v_dot2_f32_bf16 v22, v32, v8, 0
  v_dot2_f32_bf16 v22, v33, v9, v22
  v_dot2_f32_bf16 v22, v34, v10, v22
  v_dot2_f32_bf16 v22, v35, v11, v22
  s_cmp_eq_u32 s82, 1
  s_cbranch_scc1 L_k_skip
  s_add_u32 s58, s56, 24576
  s_and_b32 s58, s58, 1048575
  buffer_load_dwordx4 v[44:47], v2, s[36:39], s58 offen nt
L_k_skip:
  s_nop 0
  v_add_f32_dpp v22, v22, v22 row_ror:8 row_mask:0xf bank_mask:0xf
  s_nop 1
  v_add_f32_dpp v22, v22, v22 row_ror:4 row_mask:0xf bank_mask:0xf
  s_nop 1
  v_add_f32_dpp v22, v22, v22 row_ror:2 row_mask:0xf bank_mask:0xf
  s_nop 1
  v_add_f32_dpp v22, v22, v22 row_ror:1 row_mask:0xf bank_mask:0xf
  v_cndmask_b32_e64 v20, v20, v22, s[64:65]
  s_lshl_b64 s[64:65], s[64:65], 1
  s_waitcnt vmcnt(2)
  v_dot2_f32_bf16 v22, v36, v8, 0
  v_dot2_f32_bf16 v22, v37, v9, v22
  v_dot2_f32_bf16 v22, v38, v10, v22
  v_dot2_f32_bf16 v22, v39, v11, v22
  s_add_u32 s58, s56, 32768
  s_and_b32 s58, s58, 1048575
  buffer_load_dwordx4 v[32:35], v2, s[36:39], s58 offen nt
  v_add_f32_dpp v22, v22, v22 row_ror:8 row_mask:0xf bank_mask:0xf
  s_nop 1
  v_add_f32_dpp v22, v22, v22 row_ror:4 row_mask:0xf bank_mask:0xf
  s_nop 1
  v_add_f32_dpp v22, v22, v22 row_ror:2 row_mask:0xf bank_mask:0xf
  s_nop 1
  v_add_f32_dpp v22, v22, v22 row_ror:1 row_mask:0xf bank_mask:0xf
  v_cndmask_b32_e64 v20, v20, v22, s[64:65]
  s_lshl_b64 s[64:65], s[64:65], 1
  s_waitcnt vmcnt(2)
  v_dot2_f32_bf16 v22, v40, v8, 0
  v_dot2_f32_bf16 v22, v41, v9, v22
  v_dot2_f32_bf16 v22, v42, v10, v22
  v_dot2_f32_bf16 v22, v43, v11, v22
  s_add_u32 s58, s56, 40960
  s_and_b32 s58, s58, 1048575
  buffer_load_dwordx4 v[36:39], v2, s[36:39], s58 offen nt
  v_add_f32_dpp v22, v22, v22 row_ror:8 row_mask:0xf bank_mask:0xf
  s_nop 1
  v_add_f32_dpp v22, v22, v22 row_ror:4 row_mask:0xf bank_mask:0xf
  s_nop 1
  v_add_f32_dpp v22, v22, v22 row_ror:2 row_mask:0xf bank_mask:0xf
  s_nop 1
  v_add_f32_dpp v22, v22, v22 row_ror:1 row_mask:0xf bank_mask:0xf
  v_cndmask_b32_e64 v20, v20, v22, s[64:65]
  s_lshl_b64 s[64:65], s[64:65], 1
  s_waitcnt vmcnt(2)
  v_dot2_f32_bf16 v22, v44, v8, 0
  v_dot2_f32_bf16 v22, v45, v9, v22
  v_dot2_f32_bf16 v22, v46, v10, v22
  v_dot2_f32_bf16 v22, v47, v11, v22
  s_add_u32 s58, s56, 49152
  s_and_b32 s58, s58, 1048575
  buffer_load_dwordx4 v[40:43], v2, s[36:39], s58 offen nt
  v_add_f32_dpp v22, v22, v22 row_ror:8 row_mask:0xf bank_mask:0xf
  s_nop 1
  v_add_f32_dpp v22, v22, v22 row_ror:4 row_mask:0xf bank_mask:0xf
  s_nop 1
  v_add_f32_dpp v22, v22, v22 row_ror:2 row_mask:0xf bank_mask:0xf
  s_nop 1
  v_add_f32_dpp v22, v22, v22 row_ror:1 row_mask:0xf bank_mask:0xf
  v_cndmask_b32_e64 v20, v20, v22, s[64:65]
  s_lshl_b64 s[64:65], s[64:65], 1
  s_waitcnt vmcnt(2)
  v_dot2_f32_bf16 v22, v32, v8, 0
  v_dot2_f32_bf16 v22, v33, v9, v22
  v_dot2_f32_bf16 v22, v34, v10, v22
  v_dot2_f32_bf16 v22, v35, v11, v22
  s_add_u32 s58, s56, 57344
  s_and_b32 s58, s58, 1048575
  buffer_load_dwordx4 v[44:47], v2, s[36:39], s58 offen nt
  v_add_f32_dpp v22, v22, v22 row_ror:8 row_mask:0xf bank_mask:0xf
  s_nop 1
  v_add_f32_dpp v22, v22, v22 row_ror:4 row_mask:0xf bank_mask:0xf
  s_nop 1
  v_add_f32_dpp v22, v22, v22 row_ror:2 row_mask:0xf bank_mask:0xf
  s_nop 1
  v_add_f32_dpp v22, v22, v22 row_ror:1 row_mask:0xf bank_mask:0xf
  v_cndmask_b32_e64 v20, v20, v22, s[64:65]
  s_lshl_b64 s[64:65], s[64:65], 1
  s_waitcnt vmcnt(2)
  v_dot2_f32_bf16 v22, v36, v8, 0
  v_dot2_f32_bf16 v22, v37, v9, v22
  v_dot2_f32_bf16 v22, v38, v10, v22
  v_dot2_f32_bf16 v22, v39, v11, v22
  s_add_u32 s58, s56, 65536
  s_and_b32 s58, s58, 1048575
  buffer_load_dwordx4 v[32:35], v2, s[36:39], s58 offen nt
  v_add_f32_dpp v22, v22, v22 row_ror:8 row_mask:0xf bank_mask:0xf
  s_nop 1
  v_add_f32_dpp v22, v22, v22 row_ror:4 row_mask:0xf bank_mask:0xf
  s_nop 1
  v_add_f32_dpp v22, v22, v22 row_ror:2 row_mask:0xf bank_mask:0xf
  s_nop 1
  v_add_f32_dpp v22, v22, v22 row_ror:1 row_mask:0xf bank_mask:0xf
  v_cndmask_b32_e64 v20, v20, v22, s[64:65]
  s_lshl_b64 s[64:65], s[64:65], 1
  s_waitcnt vmcnt(2)
  v_dot2_f32_bf16 v22, v40, v8, 0
  v_dot2_f32_bf16 v22, v41, v9, v22
  v_dot2_f32_bf16 v22, v42, v10, v22
  v_dot2_f32_bf16 v22, v43, v11, v22
  s_add_u32 s58, s56, 73728
  s_and_b32 s58, s58, 1048575
  buffer_load_dwordx4 v[36:39], v2, s[36:39], s58 offen nt
  v_add_f32_dpp v22, v22, v22 row_ror:8 row_mask:0xf bank_mask:0xf
  s_nop 1
  v_add_f32_dpp v22, v22, v22 row_ror:4 row_mask:0xf bank_mask:0xf
  s_nop 1
  v_add_f32_dpp v22, v22, v22 row_ror:2 row_mask:0xf bank_mask:0xf
  s_nop 1
  v_add_f32_dpp v22, v22, v22 row_ror:1 row_mask:0xf bank_mask:0xf
  v_cndmask_b32_e64 v20, v20, v22, s[64:65]
  s_lshl_b64 s[64:65], s[64:65], 1
  s_waitcnt vmcnt(2)
  v_dot2_f32_bf16 v22, v44, v8, 0
  v_dot2_f32_bf16 v22, v45, v9, v22
  v_dot2_f32_bf16 v22, v46, v10, v22
  v_dot2_f32_bf16 v22, v47, v11, v22
  s_add_u32 s58, s56, 81920
  s_and_b32 s58, s58, 1048575
  buffer_load_dwordx4 v[40:43], v2, s[36:39], s58 offen nt
  v_add_f32_dpp v22, v22, v22 row_ror:8 row_mask:0xf bank_mask:0xf
  s_nop 1
  v_add_f32_dpp v22, v22, v22 row_ror:4 row_mask:0xf bank_mask:0xf
  s_nop 1
  v_add_f32_dpp v22, v22, v22 row_ror:2 row_mask:0xf bank_mask:0xf
  s_nop 1
  v_add_f32_dpp v22, v22, v22 row_ror:1 row_mask:0xf bank_mask:0xf
  v_cndmask_b32_e64 v20, v20, v22, s[64:65]
  s_lshl_b64 s[64:65], s[64:65], 1
  s_waitcnt vmcnt(2)
  v_dot2_f32_bf16 v22, v32, v8, 0
  v_dot2_f32_bf16 v22, v33, v9, v22
  v_dot2_f32_bf16 v22, v34, v10, v22
  v_dot2_f32_bf16 v22, v35, v11, v22
  s_add_u32 s58, s56, 90112
  s_and_b32 s58, s58, 1048575
  buffer_load_dwordx4 v[44:47], v2, s[36:39], s58 offen nt
  v_add_f32_dpp v22, v22, v22 row_ror:8 row_mask:0xf bank_mask:0xf
  s_nop 1
  v_add_f32_dpp v22, v22, v22 row_ror:4 row_mask:0xf bank_mask:0xf
  s_nop 1
  v_add_f32_dpp v22, v22, v22 row_ror:2 row_mask:0xf bank_mask:0xf
  s_nop 1
  v_add_f32_dpp v22, v22, v22 row_ror:1 row_mask:0xf bank_mask:0xf
  v_cndmask_b32_e64 v20, v20, v22, s[64:65]
  s_lshl_b64 s[64:65], s[64:65], 1
  s_waitcnt vmcnt(2)
  v_dot2_f32_bf16 v22, v36, v8, 0
  v_dot2_f32_bf16 v22, v37, v9, v22
  v_dot2_f32_bf16 v22, v38, v10, v22
  v_dot2_f32_bf16 v22, v39, v11, v22
  s_add_u32 s58, s56, 98304
  s_and_b32 s58, s58, 1048575
  buffer_load_dwordx4 v[32:35], v2, s[36:39], s58 offen nt
  v_add_f32_dpp v22, v22, v22 row_ror:8 row_mask:0xf bank_mask:0xf
  s_nop 1
  v_add_f32_dpp v22, v22, v22 row_ror:4 row_mask:0xf bank_mask:0xf
  s_nop 1
  v_add_f32_dpp v22, v22, v22 row_ror:2 row_mask:0xf bank_mask:0xf
  s_nop 1
  v_add_f32_dpp v22, v22, v22 row_ror:1 row_mask:0xf bank_mask:0xf
  v_cndmask_b32_e64 v20, v20, v22, s[64:65]
  s_lshl_b64 s[64:65], s[64:65], 1
  s_waitcnt vmcnt(2)
  v_dot2_f32_bf16 v22, v40, v8, 0
  v_dot2_f32_bf16 v22, v41, v9, v22
  v_dot2_f32_bf16 v22, v42, v10, v22
  v_dot2_f32_bf16 v22, v43, v11, v22
  s_add_u32 s58, s56, 106496
  s_and_b32 s58, s58, 1048575
  buffer_load_dwordx4 v[36:39], v2, s[36:39], s58 offen nt
  v_add_f32_dpp v22, v22, v22 row_ror:8 row_mask:0xf bank_mask:0xf
  s_nop 1
  v_add_f32_dpp v22, v22, v22 row_ror:4 row_mask:0xf bank_mask:0xf
  s_nop 1
  v_add_f32_dpp v22, v22, v22 row_ror:2 row_mask:0xf bank_mask:0xf
  s_nop 1
  v_add_f32_dpp v22, v22, v22 row_ror:1 row_mask:0xf bank_mask:0xf
  v_cndmask_b32_e64 v20, v20, v22, s[64:65]
  s_lshl_b64 s[64:65], s[64:65], 1
  s_waitcnt vmcnt(2)
  v_dot2_f32_bf16 v22, v44, v8, 0
  v_dot2_f32_bf16 v22, v45, v9, v22
  v_dot2_f32_bf16 v22, v46, v10, v22
  v_dot2_f32_bf16 v22, v47, v11, v22
  s_add_u32 s58, s56, 114688
  s_and_b32 s58, s58, 1048575
  buffer_load_dwordx4 v[40:43], v2, s[36:39], s58 offen nt
  v_add_f32_dpp v22, v22, v22 row_ror:8 row_mask:0xf bank_mask:0xf
  s_nop 1
  v_add_f32_dpp v22, v22, v22 row_ror:4 row_mask:0xf bank_mask:0xf
  s_nop 1
  v_add_f32_dpp v22, v22, v22 row_ror:2 row_mask:0xf bank_mask:0xf
  s_nop 1
  v_add_f32_dpp v22, v22, v22 row_ror:1 row_mask:0xf bank_mask:0xf
  v_cndmask_b32_e64 v20, v20, v22, s[64:65]
  s_lshl_b64 s[64:65], s[64:65], 1
  s_waitcnt vmcnt(2)
  v_dot2_f32_bf16 v22, v32, v8, 0
  v_dot2_f32_bf16 v22, v33, v9, v22
  v_dot2_f32_bf16 v22, v34, v10, v22
  v_dot2_f32_bf16 v22, v35, v11, v22
  s_add_u32 s58, s56, 122880
  s_and_b32 s58, s58, 1048575
  buffer_load_dwordx4 v[44:47], v2, s[36:39], s58 offen nt
  v_add_f32_dpp v22, v22, v22 row_ror:8 row_mask:0xf bank_mask:0xf
  s_nop 1
  v_add_f32_dpp v22, v22, v22 row_ror:4 row_mask:0xf bank_mask:0xf
  s_nop 1
  v_add_f32_dpp v22, v22, v22 row_ror:2 row_mask:0xf bank_mask:0xf
  s_nop 1
  v_add_f32_dpp v22, v22, v22 row_ror:1 row_mask:0xf bank_mask:0xf
  v_cndmask_b32_e64 v20, v20, v22, s[64:65]
  s_lshl_b64 s[64:65], s[64:65], 1
  s_waitcnt vmcnt(2)
  v_dot2_f32_bf16 v22, v36, v8, 0
  v_dot2_f32_bf16 v22, v37, v9, v22
  v_dot2_f32_bf16 v22, v38, v10, v22
  v_dot2_f32_bf16 v22, v39, v11, v22
  s_add_u32 s58, s57, 0
  s_and_b32 s58, s58, 1048575
  buffer_load_dwordx4 v[32:35], v2, s[44:47], s58 offen nt
  v_add_f32_dpp v22, v22, v22 row_ror:8 row_mask:0xf bank_mask:0xf
  s_nop 1
  v_add_f32_dpp v22, v22, v22 row_ror:4 row_mask:0xf bank_mask:0xf
  s_nop 1
  v_add_f32_dpp v22, v22, v22 row_ror:2 row_mask:0xf bank_mask:0xf
  s_nop 1
  v_add_f32_dpp v22, v22, v22 row_ror:1 row_mask:0xf bank_mask:0xf
  v_cndmask_b32_e64 v20, v20, v22, s[64:65]
  s_lshl_b64 s[64:65], s[64:65], 1
  s_waitcnt vmcnt(2)
  v_dot2_f32_bf16 v22, v40, v8, 0
  v_dot2_f32_bf16 v22, v41, v9, v22
  v_dot2_f32_bf16 v22, v42, v10, v22
  v_dot2_f32_bf16 v22, v43, v11, v22
  s_add_u32 s58, s57, 8192
  s_and_b32 s58, s58, 1048575
  buffer_load_dwordx4 v[36:39], v2, s[44:47], s58 offen nt
  v_add_f32_dpp v22, v22, v22 row_ror:8 row_mask:0xf bank_mask:0xf
  s_nop 1
  v_add_f32_dpp v22, v22, v22 row_ror:4 row_mask:0xf bank_mask:0xf
  s_nop 1
  v_add_f32_dpp v22, v22, v22 row_ror:2 row_mask:0xf bank_mask:0xf
  s_nop 1
  v_add_f32_dpp v22, v22, v22 row_ror:1 row_mask:0xf bank_mask:0xf
  v_cndmask_b32_e64 v20, v20, v22, s[64:65]
  s_lshl_b64 s[64:65], s[64:65], 1
  s_waitcnt vmcnt(2)
  v_dot2_f32_bf16 v22, v44, v8, 0
  v_dot2_f32_bf16 v22, v45, v9, v22
  v_dot2_f32_bf16 v22, v46, v10, v22
  v_dot2_f32_bf16 v22, v47, v11, v22
  s_add_u32 s58, s57, 16384
  s_and_b32 s58, s58, 1048575
  buffer_load_dwordx4 v[40:43], v2, s[44:47], s58 offen nt
  v_add_f32_dpp v22, v22, v22 row_ror:8 row_mask:0xf bank_mask:0xf
  s_nop 1
  v_add_f32_dpp v22, v22, v22 row_ror:4 row_mask:0xf bank_mask:0xf
  s_nop 1
  v_add_f32_dpp v22, v22, v22 row_ror:2 row_mask:0xf bank_mask:0xf
  s_nop 1
  v_add_f32_dpp v22, v22, v22 row_ror:1 row_mask:0xf bank_mask:0xf
  v_cndmask_b32_e64 v20, v20, v22, s[64:65]
  s_lshl_b64 s[64:65], s[64:65], 1
  s_branch L_k_tail
L_k_hi:
  s_waitcnt vmcnt(3)
  v_dot2_f32_bf16 v22, v32, v8, 0
  v_dot2_f32_bf16 v22, v33, v9, v22
  v_dot2_f32_bf16 v22, v34, v10, v22
  v_dot2_f32_bf16 v22, v35, v11, v22
  s_add_u32 s58, s56, 32768
  s_and_b32 s58, s58, 1048575
  buffer_load_dwordx4 v[32:35], v2, s[36:39], s58 offen nt
  v_add_f32_dpp v22, v22, v22 row_ror:8 row_mask:0xf bank_mask:0xf
  s_nop 1
  v_add_f32_dpp v22, v22, v22 row_ror:4 row_mask:0xf bank_mask:0xf
  s_nop 1
  v_add_f32_dpp v22, v22, v22 row_ror:2 row_mask:0xf bank_mask:0xf
  s_nop 1
  v_add_f32_dpp v22, v22, v22 row_ror:1 row_mask:0xf bank_mask:0xf
  v_cndmask_b32_e64 v20, v20, v22, s[64:65]
  s_lshl_b64 s[64:65], s[64:65], 1
  s_waitcnt vmcnt(3)
  v_dot2_f32_bf16 v22, v36, v8, 0
  v_dot2_f32_bf16 v22, v37, v9, v22
  v_dot2_f32_bf16 v22, v38, v10, v22
  v_dot2_f32_bf16 v22, v39, v11, v22
  s_add_u32 s58, s56, 40960
  s_and_b32 s58, s58, 1048575
  buffer_load_dwordx4 v[36:39], v2, s[36:39], s58 offen nt
  v_add_f32_dpp v22, v22, v22 row_ror:8 row_mask:0xf bank_mask:0xf
  s_nop 1
  v_add_f32_dpp v22, v22, v22 row_ror:4 row_mask:0xf bank_mask:0xf
  s_nop 1
  v_add_f32_dpp v22, v22, v22 row_ror:2 row_mask:0xf bank_mask:0xf
  s_nop 1
  v_add_f32_dpp v22, v22, v22 row_ror:1 row_mask:0xf bank_mask:0xf
  v_cndmask_b32_e64 v20, v20, v22, s[64:65]
  s_lshl_b64 s[64:65], s[64:65], 1
  s_waitcnt vmcnt(3)
  v_dot2_f32_bf16 v22, v40, v8, 0
  v_dot2_f32_bf16 v22, v41, v9, v22
  v_dot2_f32_bf16 v22, v42, v10, v22
  v_dot2_f32_bf16 v22, v43, v11, v22
  s_add_u32 s58, s56, 49152
  s_and_b32 s58, s58, 1048575
  buffer_load_dwordx4 v[40:43], v2, s[36:39], s58 offen nt
  v_add_f32_dpp v22, v22, v22 row_ror:8 row_mask:0xf bank_mask:0xf
  s_nop 1
  v_add_f32_dpp v22, v22, v22 row_ror:4 row_mask:0xf bank_mask:0xf
  s_nop 1
  v_add_f32_dpp v22, v22, v22 row_ror:2 row_mask:0xf bank_mask:0xf
  s_nop 1
  v_add_f32_dpp v22, v22, v22 row_ror:1 row_mask:0xf bank_mask:0xf
  v_cndmask_b32_e64 v20, v20, v22, s[64:65]
  s_lshl_b64 s[64:65], s[64:65], 1
  s_waitcnt vmcnt(3)
  v_dot2_f32_bf16 v22, v44, v8, 0
  v_dot2_f32_bf16 v22, v45, v9, v22
  v_dot2_f32_bf16 v22, v46, v10, v22
  v_dot2_f32_bf16 v22, v47, v11, v22
  s_add_u32 s58, s56, 57344
  s_and_b32 s58, s58, 1048575
  buffer_load_dwordx4 v[44:47], v2, s[36:39], s58 offen nt
  v_add_f32_dpp v22, v22, v22 row_ror:8 row_mask:0xf bank_mask:0xf
  s_nop 1
  v_add_f32_dpp v22, v22, v22 row_ror:4 row_mask:0xf bank_mask:0xf
  s_nop 1
  v_add_f32_dpp v22, v22, v22 row_ror:2 row_mask:0xf bank_mask:0xf
  s_nop 1
  v_add_f32_dpp v22, v22, v22 row_ror:1 row_mask:0xf bank_mask:0xf
  v_cndmask_b32_e64 v20, v20, v22, s[64:65]
  s_lshl_b64 s[64:65], s[64:65], 1
  s_waitcnt vmcnt(3)
  v_dot2_f32_bf16 v22, v32, v8, 0
  v_dot2_f32_bf16 v22, v33, v9, v22
  v_dot2_f32_bf16 v22, v34, v10, v22
  v_dot2_f32_bf16 v22, v35, v11, v22
  s_add_u32 s58, s56, 65536
  s_and_b32 s58, s58, 1048575
  buffer_load_dwordx4 v[32:35], v2, s[36:39], s58 offen nt
  v_add_f32_dpp v22, v22, v22 row_ror:8 row_mask:0xf bank_mask:0xf
  s_nop 1
  v_add_f32_dpp v22, v22, v22 row_ror:4 row_mask:0xf bank_mask:0xf
  s_nop 1
  v_add_f32_dpp v22, v22, v22 row_ror:2 row_mask:0xf bank_mask:0xf
  s_nop 1
  v_add_f32_dpp v22, v22, v22 row_ror:1 row_mask:0xf bank_mask:0xf
  v_cndmask_b32_e64 v20, v20, v22, s[64:65]
  s_lshl_b64 s[64:65], s[64:65], 1
  s_waitcnt vmcnt(3)
  v_dot2_f32_bf16 v22, v36, v8, 0
  v_dot2_f32_bf16 v22, v37, v9, v22
  v_dot2_f32_bf16 v22, v38, v10, v22
  v_dot2_f32_bf16 v22, v39, v11, v22
  s_add_u32 s58, s56, 73728
  s_and_b32 s58, s58, 1048575
  buffer_load_dwordx4 v[36:39], v2, s[36:39], s58 offen nt
  v_add_f32_dpp v22, v22, v22 row_ror:8 row_mask:0xf bank_mask:0xf
  s_nop 1
  v_add_f32_dpp v22, v22, v22 row_ror:4 row_mask:0xf bank_mask:0xf
  s_nop 1
  v_add_f32_dpp v22, v22, v22 row_ror:2 row_mask:0xf bank_mask:0xf
  s_nop 1
  v_add_f32_dpp v22, v22, v22 row_ror:1 row_mask:0xf bank_mask:0xf
  v_cndmask_b32_e64 v20, v20, v22, s[64:65]
  s_lshl_b64 s[64:65], s[64:65], 1
  s_waitcnt vmcnt(3)
  v_dot2_f32_bf16 v22, v40, v8, 0
  v_dot2_f32_bf16 v22, v41, v9, v22
  v_dot2_f32_bf16 v22, v42, v10, v22
  v_dot2_f32_bf16 v22, v43, v11, v22
  s_add_u32 s58, s56, 81920
  s_and_b32 s58, s58, 1048575
  buffer_load_dwordx4 v[40:43], v2, s[36:39], s58 offen nt
  v_add_f32_dpp v22, v22, v22 row_ror:8 row_mask:0xf bank_mask:0xf
  s_nop 1
  v_add_f32_dpp v22, v22, v22 row_ror:4 row_mask:0xf bank_mask:0xf
  s_nop 1
  v_add_f32_dpp v22, v22, v22 row_ror:2 row_mask:0xf bank_mask:0xf
  s_nop 1
  v_add_f32_dpp v22, v22, v22 row_ror:1 row_mask:0xf bank_mask:0xf
  v_cndmask_b32_e64 v20, v20, v22, s[64:65]
  s_lshl_b64 s[64:65], s[64:65], 1
  s_waitcnt vmcnt(3)
  v_dot2_f32_bf16 v22, v44, v8, 0
  v_dot2_f32_bf16 v22, v45, v9, v22
  v_dot2_f32_bf16 v22, v46, v10, v22
  v_dot2_f32_bf16 v22, v47, v11, v22
  s_add_u32 s58, s56, 90112
  s_and_b32 s58, s58, 1048575
  buffer_load_dwordx4 v[44:47], v2, s[36:39], s58 offen nt
  v_add_f32_dpp v22, v22, v22 row_ror:8 row_mask:0xf bank_mask:0xf
  s_nop 1
  v_add_f32_dpp v22, v22, v22 row_ror:4 row_mask:0xf bank_mask:0xf
  s_nop 1
  v_add_f32_dpp v22, v22, v22 row_ror:2 row_mask:0xf bank_mask:0xf
  s_nop 1
  v_add_f32_dpp v22, v22, v22 row_ror:1 row_mask:0xf bank_mask:0xf
  v_cndmask_b32_e64 v20, v20, v22, s[64:65]
  s_lshl_b64 s[64:65], s[64:65], 1
  s_waitcnt vmcnt(3)
  v_dot2_f32_bf16 v22, v32, v8, 0
  v_dot2_f32_bf16 v22, v33, v9, v22
  v_dot2_f32_bf16 v22, v34, v10, v22
  v_dot2_f32_bf16 v22, v35, v11, v22
  s_add_u32 s58, s56, 98304
  s_and_b32 s58, s58, 1048575
  buffer_load_dwordx4 v[32:35], v2, s[36:39], s58 offen nt
  v_add_f32_dpp v22, v22, v22 row_ror:8 row_mask:0xf bank_mask:0xf
  s_nop 1
  v_add_f32_dpp v22, v22, v22 row_ror:4 row_mask:0xf bank_mask:0xf
  s_nop 1
  v_add_f32_dpp v22, v22, v22 row_ror:2 row_mask:0xf bank_mask:0xf
  s_nop 1
  v_add_f32_dpp v22, v22, v22 row_ror:1 row_mask:0xf bank_mask:0xf
  v_cndmask_b32_e64 v20, v20, v22, s[64:65]
  s_lshl_b64 s[64:65], s[64:65], 1
  s_waitcnt vmcnt(3)
  v_dot2_f32_bf16 v22, v36, v8, 0
  v_dot2_f32_bf16 v22, v37, v9, v22
  v_dot2_f32_bf16 v22, v38, v10, v22
  v_dot2_f32_bf16 v22, v39, v11, v22
  s_add_u32 s58, s56, 106496
  s_and_b32 s58, s58, 1048575
  buffer_load_dwordx4 v[36:39], v2, s[36:39], s58 offen nt
  v_add_f32_dpp v22, v22, v22 row_ror:8 row_mask:0xf bank_mask:0xf
  s_nop 1
  v_add_f32_dpp v22, v22, v22 row_ror:4 row_mask:0xf bank_mask:0xf
  s_nop 1
  v_add_f32_dpp v22, v22, v22 row_ror:2 row_mask:0xf bank_mask:0xf
  s_nop 1
  v_add_f32_dpp v22, v22, v22 row_ror:1 row_mask:0xf bank_mask:0xf
  v_cndmask_b32_e64 v20, v20, v22, s[64:65]
  s_lshl_b64 s[64:65], s[64:65], 1
  s_waitcnt vmcnt(3)
  v_dot2_f32_bf16 v22, v40, v8, 0
  v_dot2_f32_bf16 v22, v41, v9, v22
  v_dot2_f32_bf16 v22, v42, v10, v22
  v_dot2_f32_bf16 v22, v43, v11, v22
  s_add_u32 s58, s56, 114688
  s_and_b32 s58, s58, 1048575
  buffer_load_dwordx4 v[40:43], v2, s[36:39], s58 offen nt
  v_add_f32_dpp v22, v22, v22 row_ror:8 row_mask:0xf bank_mask:0xf
  s_nop 1
  v_add_f32_dpp v22, v22, v22 row_ror:4 row_mask:0xf bank_mask:0xf
  s_nop 1
  v_add_f32_dpp v22, v22, v22 row_ror:2 row_mask:0xf bank_mask:0xf
  s_nop 1
  v_add_f32_dpp v22, v22, v22 row_ror:1 row_mask:0xf bank_mask:0xf
  v_cndmask_b32_e64 v20, v20, v22, s[64:65]
  s_lshl_b64 s[64:65], s[64:65], 1
  s_waitcnt vmcnt(3)
  v_dot2_f32_bf16 v22, v44, v8, 0
  v_dot2_f32_bf16 v22, v45, v9, v22
  v_dot2_f32_bf16 v22, v46, v10, v22
  v_dot2_f32_bf16 v22, v47, v11, v22
  s_add_u32 s58, s56, 122880
  s_and_b32 s58, s58, 1048575
  buffer_load_dwordx4 v[44:47], v2, s[36:39], s58 offen nt
  v_add_f32_dpp v22, v22, v22 row_ror:8 row_mask:0xf bank_mask:0xf
  s_nop 1
  v_add_f32_dpp v22, v22, v22 row_ror:4 row_mask:0xf bank_mask:0xf
  s_nop 1
  v_add_f32_dpp v22, v22, v22 row_ror:2 row_mask:0xf bank_mask:0xf
  s_nop 1
  v_add_f32_dpp v22, v22, v22 row_ror:1 row_mask:0xf bank_mask:0xf
  v_cndmask_b32_e64 v20, v20, v22, s[64:65]
  s_lshl_b64 s[64:65], s[64:65], 1
  s_waitcnt vmcnt(3)
  v_dot2_f32_bf16 v22, v32, v8, 0
  v_dot2_f32_bf16 v22, v33, v9, v22
  v_dot2_f32_bf16 v22, v34, v10, v22
  v_dot2_f32_bf16 v22, v35, v11, v22
  s_add_u32 s58, s57, 0
  s_and_b32 s58, s58, 1048575
  buffer_load_dwordx4 v[32:35], v2, s[44:47], s58 offen nt
  v_add_f32_dpp v22, v22, v22 row_ror:8 row_mask:0xf bank_mask:0xf
  s_nop 1
  v_add_f32_dpp v22, v22, v22 row_ror:4 row_mask:0xf bank_mask:0xf
  s_nop 1
  v_add_f32_dpp v22, v22, v22 row_ror:2 row_mask:0xf bank_mask:0xf
  s_nop 1
  v_add_f32_dpp v22, v22, v22 row_ror:1 row_mask:0xf bank_mask:0xf
  v_cndmask_b32_e64 v20, v20, v22, s[64:65]
  s_lshl_b64 s[64:65], s[64:65], 1
  s_waitcnt vmcnt(3)
  v_dot2_f32_bf16 v22, v36, v8, 0
  v_dot2_f32_bf16 v22, v37, v9, v22
  v_dot2_f32_bf16 v22, v38, v10, v22
  v_dot2_f32_bf16 v22, v39, v11, v22
  s_add_u32 s58, s57, 8192
  s_and_b32 s58, s58, 1048575
  buffer_load_dwordx4 v[36:39], v2, s[44:47], s58 offen nt
  v_add_f32_dpp v22, v22, v22 row_ror:8 row_mask:0xf bank_mask:0xf
  s_nop 1
  v_add_f32_dpp v22, v22, v22 row_ror:4 row_mask:0xf bank_mask:0xf
  s_nop 1
  v_add_f32_dpp v22, v22, v22 row_ror:2 row_mask:0xf bank_mask:0xf
  s_nop 1
  v_add_f32_dpp v22, v22, v22 row_ror:1 row_mask:0xf bank_mask:0xf
  v_cndmask_b32_e64 v20, v20, v22, s[64:65]
  s_lshl_b64 s[64:65], s[64:65], 1
  s_waitcnt vmcnt(3)
  v_dot2_f32_bf16 v22, v40, v8, 0
  v_dot2_f32_bf16 v22, v41, v9, v22
  v_dot2_f32_bf16 v22, v42, v10, v22
  v_dot2_f32_bf16 v22, v43, v11, v22
  s_add_u32 s58, s57, 16384
  s_and_b32 s58, s58, 1048575
  buffer_load_dwordx4 v[40:43], v2, s[44:47], s58 offen nt
  v_add_f32_dpp v22, v22, v22 row_ror:8 row_mask:0xf bank_mask:0xf
  s_nop 1
  v_add_f32_dpp v22, v22, v22 row_ror:4 row_mask:0xf bank_mask:0xf
  s_nop 1
  v_add_f32_dpp v22, v22, v22 row_ror:2 row_mask:0xf bank_mask:0xf
  s_nop 1
  v_add_f32_dpp v22, v22, v22 row_ror:1 row_mask:0xf bank_mask:0xf
  v_cndmask_b32_e64 v20, v20, v22, s[64:65]
  s_lshl_b64 s[64:65], s[64:65], 1
  s_waitcnt vmcnt(3)
  v_dot2_f32_bf16 v22, v44, v8, 0
  v_dot2_f32_bf16 v22, v45, v9, v22
  v_dot2_f32_bf16 v22, v46, v10, v22
  v_dot2_f32_bf16 v22, v47, v11, v22
  s_add_u32 s58, s57, 24576
  s_and_b32 s58, s58, 1048575
  buffer_load_dwordx4 v[44:47], v2, s[44:47], s58 offen nt
  v_add_f32_dpp v22, v22, v22 row_ror:8 row_mask:0xf bank_mask:0xf
  s_nop 1
  v_add_f32_dpp v22, v22, v22 row_ror:4 row_mask:0xf bank_mask:0xf
  s_nop 1
  v_add_f32_dpp v22, v22, v22 row_ror:2 row_mask:0xf bank_mask:0xf
  s_nop 1
  v_add_f32_dpp v22, v22, v22 row_ror:1 row_mask:0xf bank_mask:0xf
  v_cndmask_b32_e64 v20, v20, v22, s[64:65]
  s_lshl_b64 s[64:65], s[64:65], 1
L_k_tail:
  v_mul_f32 v20, s62, v20
  v_max_f32 v21, v21, v20
  ds_write_b32 v164, v20 offset:10752
  v_add_u32 v164, 256, v164
  v_mov_b32 v28, 0
  v_mov_b32 v29, 1
  v_cmp_eq_u32 vcc, 0, v0
  s_and_saveexec_b64 s[70:71], vcc
  ds_add_u32 v28, v29 offset:4604
  s_mov_b64 exec, s[70:71]
  s_add_u32 s56, s56, 131072
  s_add_u32 s59, s59, 1
  s_cmp_lt_u32 s59, 8
  s_cbranch_scc1 L_kloop
  v_subrev_u32 v164, 2048, v164
  ds_read_b32 v24, v164 offset:10752
  ds_read_b32 v25, v164 offset:11008
  ds_read_b32 v26, v164 offset:11264
  ds_read_b32 v27, v164 offset:11520
  ds_read_b32 v28, v164 offset:11776
  ds_read_b32 v29, v164 offset:12032
  ds_read_b32 v30, v164 offset:12288
  ds_read_b32 v31, v164 offset:12544
  s_nop 1
  v_max_f32_dpp v21, v21, v21 row_ror:8 row_mask:0xf bank_mask:0xf
  s_nop 1
  v_max_f32_dpp v21, v21, v21 row_ror:4 row_mask:0xf bank_mask:0xf
  s_nop 1
  v_max_f32_dpp v21, v21, v21 row_ror:2 row_mask:0xf bank_mask:0xf
  s_nop 1
  v_max_f32_dpp v21, v21, v21 row_ror:1 row_mask:0xf bank_mask:0xf
  v_mov_b32 v22, v21
  s_nop 1
  v_permlane16_swap_b32 v21, v22
  s_nop 0
  v_max_f32 v21, v21, v22
  v_mov_b32 v22, v21
  s_nop 1
  v_permlane32_swap_b32 v21, v22
  s_nop 0
  v_max_f32 v21, v21, v22
  s_waitcnt lgkmcnt(0)
  v_sub_f32 v24, v24, v21
  v_sub_f32 v25, v25, v21
  v_sub_f32 v26, v26, v21
  v_sub_f32 v27, v27, v21
  v_sub_f32 v28, v28, v21
  v_sub_f32 v29, v29, v21
  v_sub_f32 v30, v30, v21
  v_sub_f32 v31, v31, v21
  v_exp_f32 v24, v24
  v_exp_f32 v25, v25
  v_exp_f32 v26, v26
  v_exp_f32 v27, v27
  v_exp_f32 v28, v28
  v_exp_f32 v29, v29
  v_exp_f32 v30, v30
  v_exp_f32 v31, v31
  s_nop 0
  v_add_f32 v23, v24, v25
  v_add_f32 v23, v23, v26
  v_add_f32 v23, v23, v27
  v_add_f32 v23, v23, v28
  v_add_f32 v23, v23, v29
  v_add_f32 v23, v23, v30
  v_add_f32 v23, v23, v31
  v_cvt_pk_bf16_f32 v24, v24, v24
  v_cvt_pk_bf16_f32 v25, v25, v25
  v_cvt_pk_bf16_f32 v26, v26, v26
  v_cvt_pk_bf16_f32 v27, v27, v27
  v_cvt_pk_bf16_f32 v28, v28, v28
  v_cvt_pk_bf16_f32 v29, v29, v29
  v_cvt_pk_bf16_f32 v30, v30, v30
  v_cvt_pk_bf16_f32 v31, v31, v31
  ds_write_b32 v164, v24 offset:10752
  ds_write_b32 v164, v25 offset:11008
  ds_write_b32 v164, v26 offset:11264
  ds_write_b32 v164, v27 offset:11520
  ds_write_b32 v164, v28 offset:11776
  ds_write_b32 v164, v29 offset:12032
  ds_write_b32 v164, v30 offset:12288
  ds_write_b32 v164, v31 offset:12544
  s_nop 1
  v_add_f32_dpp v23, v23, v23 row_ror:8 row_mask:0xf bank_mask:0xf
  s_nop 1
  v_add_f32_dpp v23, v23, v23 row_ror:4 row_mask:0xf bank_mask:0xf
  s_nop 1
  v_add_f32_dpp v23, v23, v23 row_ror:2 row_mask:0xf bank_mask:0xf
  s_nop 1
  v_add_f32_dpp v23, v23, v23 row_ror:1 row_mask:0xf bank_mask:0xf
  v_mov_b32 v22, v23
  s_nop 1
  v_permlane16_swap_b32 v23, v22
  s_nop 0
  v_add_f32 v23, v23, v22
  v_mov_b32 v22, v23
  s_nop 1
  v_permlane32_swap_b32 v23, v22
  s_nop 0
  v_add_f32 v23, v23, v22
  v_mov_b32 v24, v21
  v_mov_b32 v25, v23
  s_lshl_b32 s35, s3, 3
  v_mov_b32 v26, s35
  v_mov_b32 v27, 1
  v_mov_b32 v28, 0
  v_cmp_eq_u32 vcc, 0, v0
  s_and_saveexec_b64 s[70:71], vcc
  ds_write_b64 v26, v[24:25] offset:4512
  ds_add_u32 v28, v27 offset:4576
  s_mov_b64 exec, s[70:71]
  s_mov_b32 s56, s68
  s_mov_b32 s59, 0
  v_mov_b32 v12, 0
  v_mov_b32 v13, 0
  v_mov_b32 v14, 0
  v_mov_b32 v15, 0
  v_mov_b32 v156, 0
  v_and_b32 v157, 3, v0
  v_lshl_add_u32 v157, v163, 2, v157
  s_lshl_b32 s35, s3, 4
  v_add_u32 v157, s35, v157
  v_lshlrev_b32 v157, 2, v157
  v_and_b32 v158, 15, v0
  v_lshlrev_b32 v158, 5, v158
  v_lshl_add_u32 v158, v163, 4, v158
  s_lshl_b32 s35, s3, 14
  s_add_u32 s35, s35, 27136
  v_add_u32 v158, s35, v158
  v_lshlrev_b32 v159, 2, v165
  s_lshl_b32 s35, s30, 6
  s_add_u32 s35, s35, s33
  s_lshl_b32 s35, s35, 11
  v_add_u32 v160, s35, v159
L_vloop:
  ds_read_b32 v20, v164 offset:10752
  v_add_u32 v164, 256, v164
  s_add_u32 s57, s56, 131072
  s_cmp_lg_u32 s59, 7
  s_cbranch_scc1 L_vbody
  s_mov_b32 s46, 0
  v_mov_b32 v24, 0
L_wo_spin:
  ds_read_b32 v25, v24 offset:4580
  s_waitcnt lgkmcnt(0)
  v_readfirstlane_b32 s35, v25
  s_cmp_ge_u32 s35, 2
  s_cbranch_scc1 L_wo_ok
  s_sleep 2
  s_sub_u32 s63, s63, 1
  s_cmp_gt_i32 s63, 0
  s_cbranch_scc1 L_wo_spin
L_wo_ok:
  s_lshl_b32 s35, s3, 14
  s_add_u32 s35, s35, 27136
  v_lshl_add_u32 v24, v0, 4, s35
  ds_read_b128 v[48:51], v24 offset:0
  ds_read_b128 v[52:55], v24 offset:1024
  ds_read_b128 v[56:59], v24 offset:2048
  ds_read_b128 v[60:63], v24 offset:3072
  ds_read_b128 v[64:67], v24 offset:4096
  ds_read_b128 v[68:71], v24 offset:5120
  ds_read_b128 v[72:75], v24 offset:6144
  ds_read_b128 v[76:79], v24 offset:7168
  ds_read_b128 v[80:83], v24 offset:8192
  ds_read_b128 v[84:87], v24 offset:9216
  ds_read_b128 v[88:91], v24 offset:10240
  ds_read_b128 v[92:95], v24 offset:11264
  ds_read_b128 v[96:99], v24 offset:12288
  ds_read_b128 v[100:103], v24 offset:13312
  ds_read_b128 v[104:107], v24 offset:14336
  ds_read_b128 v[108:111], v24 offset:15360
  s_lshl_b32 s35, s3, 2
  v_mov_b32 v24, s35
  ds_read_b32 v156, v24 offset:4480
L_vbody:
  v_mov_b32 v28, 0
  ds_read_b32 v29, v28 offset:4600
  s_waitcnt lgkmcnt(0)
  v_readfirstlane_b32 s79, v29
  s_add_u32 s35, s59, 8
  s_lshr_b32 s35, s81, s35
  s_and_b32 s35, s35, 1
  s_or_b32 s79, s79, s35
  s_mov_b32 s82, 0
  s_cmp_eq_u32 s79, s80
  s_cbranch_scc1 L_v_same
  s_cmp_eq_u32 s79, 0
  s_cbranch_scc1 L_v_down
  s_add_u32 s58, s56, 24576
  s_and_b32 s58, s58, 1048575
  buffer_load_dwordx4 v[44:47], v2, s[40:43], s58 offen nt
  s_branch L_v_same
L_v_down:
  s_mov_b32 s82, 1
L_v_same:
  s_mov_b32 s80, s79
  s_cmp_eq_u32 s79, 1
  s_cbranch_scc1 L_v_hi
  v_and_b32_dpp v16, v20, v4 row_newbcast:0 row_mask:0xf bank_mask:0xf
  v_and_b32_dpp v17, v20, v5 row_newbcast:0 row_mask:0xf bank_mask:0xf
  v_and_b32_dpp v18, v20, v6 row_newbcast:0 row_mask:0xf bank_mask:0xf
  v_and_b32_dpp v19, v20, v7 row_newbcast:0 row_mask:0xf bank_mask:0xf
  s_waitcnt vmcnt(2)
  s_nop 0
  v_mfma_f32_16x16x32_bf16 v[12:15], v[16:19], v[32:35], v[12:15]
  s_cmp_eq_u32 s82, 1
  s_cbranch_scc1 L_v_skip
  s_add_u32 s58, s56, 24576
  s_and_b32 s58, s58, 1048575
  buffer_load_dwordx4 v[44:47], v2, s[40:43], s58 offen nt
L_v_skip:
  v_and_b32_dpp v16, v20, v4 row_newbcast:1 row_mask:0xf bank_mask:0xf
  v_and_b32_dpp v17, v20, v5 row_newbcast:1 row_mask:0xf bank_mask:0xf
  v_and_b32_dpp v18, v20, v6 row_newbcast:1 row_mask:0xf bank_mask:0xf
  v_and_b32_dpp v19, v20, v7 row_newbcast:1 row_mask:0xf bank_mask:0xf
  s_waitcnt vmcnt(2)
  s_nop 0
  v_mfma_f32_16x16x32_bf16 v[12:15], v[16:19], v[36:39], v[12:15]
  s_add_u32 s58, s56, 32768
  s_and_b32 s58, s58, 1048575
  buffer_load_dwordx4 v[32:35], v2, s[40:43], s58 offen nt
  v_and_b32_dpp v16, v20, v4 row_newbcast:2 row_mask:0xf bank_mask:0xf
  v_and_b32_dpp v17, v20, v5 row_newbcast:2 row_mask:0xf bank_mask:0xf
  v_and_b32_dpp v18, v20, v6 row_newbcast:2 row_mask:0xf bank_mask:0xf
  v_and_b32_dpp v19, v20, v7 row_newbcast:2 row_mask:0xf bank_mask:0xf
  s_waitcnt vmcnt(2)
  s_nop 0
  v_mfma_f32_16x16x32_bf16 v[12:15], v[16:19], v[40:43], v[12:15]
  s_add_u32 s58, s56, 40960
  s_and_b32 s58, s58, 1048575
  buffer_load_dwordx4 v[36:39], v2, s[40:43], s58 offen nt
  v_and_b32_dpp v16, v20, v4 row_newbcast:3 row_mask:0xf bank_mask:0xf
  v_and_b32_dpp v17, v20, v5 row_newbcast:3 row_mask:0xf bank_mask:0xf
  v_and_b32_dpp v18, v20, v6 row_newbcast:3 row_mask:0xf bank_mask:0xf
  v_and_b32_dpp v19, v20, v7 row_newbcast:3 row_mask:0xf bank_mask:0xf
  s_waitcnt vmcnt(2)
  s_nop 0
  v_mfma_f32_16x16x32_bf16 v[12:15], v[16:19], v[44:47], v[12:15]
  s_add_u32 s58, s56, 49152
  s_and_b32 s58, s58, 1048575
  buffer_load_dwordx4 v[40:43], v2, s[40:43], s58 offen nt
  v_and_b32_dpp v16, v20, v4 row_newbcast:4 row_mask:0xf bank_mask:0xf
  v_and_b32_dpp v17, v20, v5 row_newbcast:4 row_mask:0xf bank_mask:0xf
  v_and_b32_dpp v18, v20, v6 row_newbcast:4 row_mask:0xf bank_mask:0xf
  v_and_b32_dpp v19, v20, v7 row_newbcast:4 row_mask:0xf bank_mask:0xf
  s_waitcnt vmcnt(2)
  s_nop 0
  v_mfma_f32_16x16x32_bf16 v[12:15], v[16:19], v[32:35], v[12:15]
  s_add_u32 s58, s56, 57344
  s_and_b32 s58, s58, 1048575
  buffer_load_dwordx4 v[44:47], v2, s[40:43], s58 offen nt
  v_and_b32_dpp v16, v20, v4 row_newbcast:5 row_mask:0xf bank_mask:0xf
  v_and_b32_dpp v17, v20, v5 row_newbcast:5 row_mask:0xf bank_mask:0xf
  v_and_b32_dpp v18, v20, v6 row_newbcast:5 row_mask:0xf bank_mask:0xf
  v_and_b32_dpp v19, v20, v7 row_newbcast:5 row_mask:0xf bank_mask:0xf
  s_waitcnt vmcnt(2)
  s_nop 0
  v_mfma_f32_16x16x32_bf16 v[12:15], v[16:19], v[36:39], v[12:15]
  s_add_u32 s58, s56, 65536
  s_and_b32 s58, s58, 1048575
  buffer_load_dwordx4 v[32:35], v2, s[40:43], s58 offen nt
  v_and_b32_dpp v16, v20, v4 row_newbcast:6 row_mask:0xf bank_mask:0xf
  v_and_b32_dpp v17, v20, v5 row_newbcast:6 row_mask:0xf bank_mask:0xf
  v_and_b32_dpp v18, v20, v6 row_newbcast:6 row_mask:0xf bank_mask:0xf
  v_and_b32_dpp v19, v20, v7 row_newbcast:6 row_mask:0xf bank_mask:0xf
  s_waitcnt vmcnt(2)
  s_nop 0
  v_mfma_f32_16x16x32_bf16 v[12:15], v[16:19], v[40:43], v[12:15]
  s_add_u32 s58, s56, 73728
  s_and_b32 s58, s58, 1048575
  buffer_load_dwordx4 v[36:39], v2, s[40:43], s58 offen nt
  v_and_b32_dpp v16, v20, v4 row_newbcast:7 row_mask:0xf bank_mask:0xf
  v_and_b32_dpp v17, v20, v5 row_newbcast:7 row_mask:0xf bank_mask:0xf
  v_and_b32_dpp v18, v20, v6 row_newbcast:7 row_mask:0xf bank_mask:0xf
  v_and_b32_dpp v19, v20, v7 row_newbcast:7 row_mask:0xf bank_mask:0xf
  s_waitcnt vmcnt(2)
  s_nop 0
  v_mfma_f32_16x16x32_bf16 v[12:15], v[16:19], v[44:47], v[12:15]
  s_add_u32 s58, s56, 81920
  s_and_b32 s58, s58, 1048575
  buffer_load_dwordx4 v[40:43], v2, s[40:43], s58 offen nt
  v_and_b32_dpp v16, v20, v4 row_newbcast:8 row_mask:0xf bank_mask:0xf
  v_and_b32_dpp v17, v20, v5 row_newbcast:8 row_mask:0xf bank_mask:0xf
  v_and_b32_dpp v18, v20, v6 row_newbcast:8 row_mask:0xf bank_mask:0xf
  v_and_b32_dpp v19, v20, v7 row_newbcast:8 row_mask:0xf bank_mask:0xf
  s_waitcnt vmcnt(2)
  s_nop 0
  v_mfma_f32_16x16x32_bf16 v[12:15], v[16:19], v[32:35], v[12:15]
  s_add_u32 s58, s56, 90112
  s_and_b32 s58, s58, 1048575
  buffer_load_dwordx4 v[44:47], v2, s[40:43], s58 offen nt
  v_and_b32_dpp v16, v20, v4 row_newbcast:9 row_mask:0xf bank_mask:0xf
  v_and_b32_dpp v17, v20, v5 row_newbcast:9 row_mask:0xf bank_mask:0xf
  v_and_b32_dpp v18, v20, v6 row_newbcast:9 row_mask:0xf bank_mask:0xf
  v_and_b32_dpp v19, v20, v7 row_newbcast:9 row_mask:0xf bank_mask:0xf
  s_waitcnt vmcnt(2)
  s_nop 0
  v_mfma_f32_16x16x32_bf16 v[12:15], v[16:19], v[36:39], v[12:15]
  s_add_u32 s58, s56, 98304
  s_and_b32 s58, s58, 1048575
  buffer_load_dwordx4 v[32:35], v2, s[40:43], s58 offen nt
  v_and_b32_dpp v16, v20, v4 row_newbcast:10 row_mask:0xf bank_mask:0xf
  v_and_b32_dpp v17, v20, v5 row_newbcast:10 row_mask:0xf bank_mask:0xf
  v_and_b32_dpp v18, v20, v6 row_newbcast:10 row_mask:0xf bank_mask:0xf
  v_and_b32_dpp v19, v20, v7 row_newbcast:10 row_mask:0xf bank_mask:0xf
  s_waitcnt vmcnt(2)
  s_nop 0
  v_mfma_f32_16x16x32_bf16 v[12:15], v[16:19], v[40:43], v[12:15]
  s_add_u32 s58, s56, 106496
  s_and_b32 s58, s58, 1048575
  buffer_load_dwordx4 v[36:39], v2, s[40:43], s58 offen nt
  v_and_b32_dpp v16, v20, v4 row_newbcast:11 row_mask:0xf bank_mask:0xf
  v_and_b32_dpp v17, v20, v5 row_newbcast:11 row_mask:0xf bank_mask:0xf
  v_and_b32_dpp v18, v20, v6 row_newbcast:11 row_mask:0xf bank_mask:0xf
  v_and_b32_dpp v19, v20, v7 row_newbcast:11 row_mask:0xf bank_mask:0xf
  s_waitcnt vmcnt(2)
  s_nop 0
  v_mfma_f32_16x16x32_bf16 v[12:15], v[16:19], v[44:47], v[12:15]
  s_add_u32 s58, s56, 114688
  s_and_b32 s58, s58, 1048575
  buffer_load_dwordx4 v[40:43], v2, s[40:43], s58 offen nt
  v_and_b32_dpp v16, v20, v4 row_newbcast:12 row_mask:0xf bank_mask:0xf
  v_and_b32_dpp v17, v20, v5 row_newbcast:12 row_mask:0xf bank_mask:0xf
  v_and_b32_dpp v18, v20, v6 row_newbcast:12 row_mask:0xf bank_mask:0xf
  v_and_b32_dpp v19, v20, v7 row_newbcast:12 row_mask:0xf bank_mask:0xf
  s_waitcnt vmcnt(2)
  s_nop 0
  v_mfma_f32_16x16x32_bf16 v[12:15], v[16:19], v[32:35], v[12:15]
  s_add_u32 s58, s56, 122880
  s_and_b32 s58, s58, 1048575
  buffer_load_dwordx4 v[44:47], v2, s[40:43], s58 offen nt
  v_and_b32_dpp v16, v20, v4 row_newbcast:13 row_mask:0xf bank_mask:0xf
  v_and_b32_dpp v17, v20, v5 row_newbcast:13 row_mask:0xf bank_mask:0xf
  v_and_b32_dpp v18, v20, v6 row_newbcast:13 row_mask:0xf bank_mask:0xf
  v_and_b32_dpp v19, v20, v7 row_newbcast:13 row_mask:0xf bank_mask:0xf
  s_waitcnt vmcnt(2)
  s_nop 0
  v_mfma_f32_16x16x32_bf16 v[12:15], v[16:19], v[36:39], v[12:15]
  s_add_u32 s58, s57, 0
  s_and_b32 s58, s58, 1048575
  buffer_load_dwordx4 v[32:35], v2, s[44:47], s58 offen nt
  v_and_b32_dpp v16, v20, v4 row_newbcast:14 row_mask:0xf bank_mask:0xf
  v_and_b32_dpp v17, v20, v5 row_newbcast:14 row_mask:0xf bank_mask:0xf
  v_and_b32_dpp v18, v20, v6 row_newbcast:14 row_mask:0xf bank_mask:0xf
  v_and_b32_dpp v19, v20, v7 row_newbcast:14 row_mask:0xf bank_mask:0xf
  s_waitcnt vmcnt(2)
  s_nop 0
  v_mfma_f32_16x16x32_bf16 v[12:15], v[16:19], v[40:43], v[12:15]
  s_add_u32 s58, s57, 8192
  s_and_b32 s58, s58, 1048575
  buffer_load_dwordx4 v[36:39], v2, s[44:47], s58 offen nt
  v_and_b32_dpp v16, v20, v4 row_newbcast:15 row_mask:0xf bank_mask:0xf
  v_and_b32_dpp v17, v20, v5 row_newbcast:15 row_mask:0xf bank_mask:0xf
  v_and_b32_dpp v18, v20, v6 row_newbcast:15 row_mask:0xf bank_mask:0xf
  v_and_b32_dpp v19, v20, v7 row_newbcast:15 row_mask:0xf bank_mask:0xf
  s_waitcnt vmcnt(2)
  s_nop 0
  v_mfma_f32_16x16x32_bf16 v[12:15], v[16:19], v[44:47], v[12:15]
  s_add_u32 s58, s57, 16384
  s_and_b32 s58, s58, 1048575
  buffer_load_dwordx4 v[40:43], v2, s[44:47], s58 offen nt
  s_branch L_v_tail
L_v_hi:
  v_and_b32_dpp v16, v20, v4 row_newbcast:0 row_mask:0xf bank_mask:0xf
  v_and_b32_dpp v17, v20, v5 row_newbcast:0 row_mask:0xf bank_mask:0xf
  v_and_b32_dpp v18, v20, v6 row_newbcast:0 row_mask:0xf bank_mask:0xf
  v_and_b32_dpp v19, v20, v7 row_newbcast:0 row_mask:0xf bank_mask:0xf
  s_waitcnt vmcnt(3)
  s_nop 0
  v_mfma_f32_16x16x32_bf16 v[12:15], v[16:19], v[32:35], v[12:15]
  s_add_u32 s58, s56, 32768
  s_and_b32 s58, s58, 1048575
  buffer_load_dwordx4 v[32:35], v2, s[40:43], s58 offen nt
  v_and_b32_dpp v16, v20, v4 row_newbcast:1 row_mask:0xf bank_mask:0xf
  v_and_b32_dpp v17, v20, v5 row_newbcast:1 row_mask:0xf bank_mask:0xf
  v_and_b32_dpp v18, v20, v6 row_newbcast:1 row_mask:0xf bank_mask:0xf
  v_and_b32_dpp v19, v20, v7 row_newbcast:1 row_mask:0xf bank_mask:0xf
  s_waitcnt vmcnt(3)
  s_nop 0
  v_mfma_f32_16x16x32_bf16 v[12:15], v[16:19], v[36:39], v[12:15]
  s_add_u32 s58, s56, 40960
  s_and_b32 s58, s58, 1048575
  buffer_load_dwordx4 v[36:39], v2, s[40:43], s58 offen nt
  v_and_b32_dpp v16, v20, v4 row_newbcast:2 row_mask:0xf bank_mask:0xf
  v_and_b32_dpp v17, v20, v5 row_newbcast:2 row_mask:0xf bank_mask:0xf
  v_and_b32_dpp v18, v20, v6 row_newbcast:2 row_mask:0xf bank_mask:0xf
  v_and_b32_dpp v19, v20, v7 row_newbcast:2 row_mask:0xf bank_mask:0xf
  s_waitcnt vmcnt(3)
  s_nop 0
  v_mfma_f32_16x16x32_bf16 v[12:15], v[16:19], v[40:43], v[12:15]
  s_add_u32 s58, s56, 49152
  s_and_b32 s58, s58, 1048575
  buffer_load_dwordx4 v[40:43], v2, s[40:43], s58 offen nt
  v_and_b32_dpp v16, v20, v4 row_newbcast:3 row_mask:0xf bank_mask:0xf
  v_and_b32_dpp v17, v20, v5 row_newbcast:3 row_mask:0xf bank_mask:0xf
  v_and_b32_dpp v18, v20, v6 row_newbcast:3 row_mask:0xf bank_mask:0xf
  v_and_b32_dpp v19, v20, v7 row_newbcast:3 row_mask:0xf bank_mask:0xf
  s_waitcnt vmcnt(3)
  s_nop 0
  v_mfma_f32_16x16x32_bf16 v[12:15], v[16:19], v[44:47], v[12:15]
  s_add_u32 s58, s56, 57344
  s_and_b32 s58, s58, 1048575
  buffer_load_dwordx4 v[44:47], v2, s[40:43], s58 offen nt
  v_and_b32_dpp v16, v20, v4 row_newbcast:4 row_mask:0xf bank_mask:0xf
  v_and_b32_dpp v17, v20, v5 row_newbcast:4 row_mask:0xf bank_mask:0xf
  v_and_b32_dpp v18, v20, v6 row_newbcast:4 row_mask:0xf bank_mask:0xf
  v_and_b32_dpp v19, v20, v7 row_newbcast:4 row_mask:0xf bank_mask:0xf
  s_waitcnt vmcnt(3)
  s_nop 0
  v_mfma_f32_16x16x32_bf16 v[12:15], v[16:19], v[32:35], v[12:15]
  s_add_u32 s58, s56, 65536
  s_and_b32 s58, s58, 1048575
  buffer_load_dwordx4 v[32:35], v2, s[40:43], s58 offen nt
  v_and_b32_dpp v16, v20, v4 row_newbcast:5 row_mask:0xf bank_mask:0xf
  v_and_b32_dpp v17, v20, v5 row_newbcast:5 row_mask:0xf bank_mask:0xf
  v_and_b32_dpp v18, v20, v6 row_newbcast:5 row_mask:0xf bank_mask:0xf
  v_and_b32_dpp v19, v20, v7 row_newbcast:5 row_mask:0xf bank_mask:0xf
  s_waitcnt vmcnt(3)
  s_nop 0
  v_mfma_f32_16x16x32_bf16 v[12:15], v[16:19], v[36:39], v[12:15]
  s_add_u32 s58, s56, 73728
  s_and_b32 s58, s58, 1048575
  buffer_load_dwordx4 v[36:39], v2, s[40:43], s58 offen nt
  v_and_b32_dpp v16, v20, v4 row_newbcast:6 row_mask:0xf bank_mask:0xf
  v_and_b32_dpp v17, v20, v5 row_newbcast:6 row_mask:0xf bank_mask:0xf
  v_and_b32_dpp v18, v20, v6 row_newbcast:6 row_mask:0xf bank_mask:0xf
  v_and_b32_dpp v19, v20, v7 row_newbcast:6 row_mask:0xf bank_mask:0xf
  s_waitcnt vmcnt(3)
  s_nop 0
  v_mfma_f32_16x16x32_bf16 v[12:15], v[16:19], v[40:43], v[12:15]
  s_add_u32 s58, s56, 81920
  s_and_b32 s58, s58, 1048575
  buffer_load_dwordx4 v[40:43], v2, s[40:43], s58 offen nt
  v_and_b32_dpp v16, v20, v4 row_newbcast:7 row_mask:0xf bank_mask:0xf
  v_and_b32_dpp v17, v20, v5 row_newbcast:7 row_mask:0xf bank_mask:0xf
  v_and_b32_dpp v18, v20, v6 row_newbcast:7 row_mask:0xf bank_mask:0xf
  v_and_b32_dpp v19, v20, v7 row_newbcast:7 row_mask:0xf bank_mask:0xf
  s_waitcnt vmcnt(3)
  s_nop 0
  v_mfma_f32_16x16x32_bf16 v[12:15], v[16:19], v[44:47], v[12:15]
  s_add_u32 s58, s56, 90112
  s_and_b32 s58, s58, 1048575
  buffer_load_dwordx4 v[44:47], v2, s[40:43], s58 offen nt
  v_and_b32_dpp v16, v20, v4 row_newbcast:8 row_mask:0xf bank_mask:0xf
  v_and_b32_dpp v17, v20, v5 row_newbcast:8 row_mask:0xf bank_mask:0xf
  v_and_b32_dpp v18, v20, v6 row_newbcast:8 row_mask:0xf bank_mask:0xf
  v_and_b32_dpp v19, v20, v7 row_newbcast:8 row_mask:0xf bank_mask:0xf
  s_waitcnt vmcnt(3)
  s_nop 0
  v_mfma_f32_16x16x32_bf16 v[12:15], v[16:19], v[32:35], v[12:15]
  s_add_u32 s58, s56, 98304
  s_and_b32 s58, s58, 1048575
  buffer_load_dwordx4 v[32:35], v2, s[40:43], s58 offen nt
  v_and_b32_dpp v16, v20, v4 row_newbcast:9 row_mask:0xf bank_mask:0xf
  v_and_b32_dpp v17, v20, v5 row_newbcast:9 row_mask:0xf bank_mask:0xf
  v_and_b32_dpp v18, v20, v6 row_newbcast:9 row_mask:0xf bank_mask:0xf
  v_and_b32_dpp v19, v20, v7 row_newbcast:9 row_mask:0xf bank_mask:0xf
  s_waitcnt vmcnt(3)
  s_nop 0
  v_mfma_f32_16x16x32_bf16 v[12:15], v[16:19], v[36:39], v[12:15]
  s_add_u32 s58, s56, 106496
  s_and_b32 s58, s58, 1048575
  buffer_load_dwordx4 v[36:39], v2, s[40:43], s58 offen nt
  v_and_b32_dpp v16, v20, v4 row_newbcast:10 row_mask:0xf bank_mask:0xf
  v_and_b32_dpp v17, v20, v5 row_newbcast:10 row_mask:0xf bank_mask:0xf
  v_and_b32_dpp v18, v20, v6 row_newbcast:10 row_mask:0xf bank_mask:0xf
  v_and_b32_dpp v19, v20, v7 row_newbcast:10 row_mask:0xf bank_mask:0xf
  s_waitcnt vmcnt(3)
  s_nop 0
  v_mfma_f32_16x16x32_bf16 v[12:15], v[16:19], v[40:43], v[12:15]
  s_add_u32 s58, s56, 114688
  s_and_b32 s58, s58, 1048575
  buffer_load_dwordx4 v[40:43], v2, s[40:43], s58 offen nt
  v_and_b32_dpp v16, v20, v4 row_newbcast:11 row_mask:0xf bank_mask:0xf
  v_and_b32_dpp v17, v20, v5 row_newbcast:11 row_mask:0xf bank_mask:0xf
  v_and_b32_dpp v18, v20, v6 row_newbcast:11 row_mask:0xf bank_mask:0xf
  v_and_b32_dpp v19, v20, v7 row_newbcast:11 row_mask:0xf bank_mask:0xf
  s_waitcnt vmcnt(3)
  s_nop 0
  v_mfma_f32_16x16x32_bf16 v[12:15], v[16:19], v[44:47], v[12:15]
  s_add_u32 s58, s56, 122880
  s_and_b32 s58, s58, 1048575
  buffer_load_dwordx4 v[44:47], v2, s[40:43], s58 offen nt
  v_and_b32_dpp v16, v20, v4 row_newbcast:12 row_mask:0xf bank_mask:0xf
  v_and_b32_dpp v17, v20, v5 row_newbcast:12 row_mask:0xf bank_mask:0xf
  v_and_b32_dpp v18, v20, v6 row_newbcast:12 row_mask:0xf bank_mask:0xf
  v_and_b32_dpp v19, v20, v7 row_newbcast:12 row_mask:0xf bank_mask:0xf
  s_waitcnt vmcnt(3)
  s_nop 0
  v_mfma_f32_16x16x32_bf16 v[12:15], v[16:19], v[32:35], v[12:15]
  s_add_u32 s58, s57, 0
  s_and_b32 s58, s58, 1048575
  buffer_load_dwordx4 v[32:35], v2, s[44:47], s58 offen nt
  v_and_b32_dpp v16, v20, v4 row_newbcast:13 row_mask:0xf bank_mask:0xf
  v_and_b32_dpp v17, v20, v5 row_newbcast:13 row_mask:0xf bank_mask:0xf
  v_and_b32_dpp v18, v20, v6 row_newbcast:13 row_mask:0xf bank_mask:0xf
  v_and_b32_dpp v19, v20, v7 row_newbcast:13 row_mask:0xf bank_mask:0xf
  s_waitcnt vmcnt(3)
  s_nop 0
  v_mfma_f32_16x16x32_bf16 v[12:15], v[16:19], v[36:39], v[12:15]
  s_add_u32 s58, s57, 8192
  s_and_b32 s58, s58, 1048575
  buffer_load_dwordx4 v[36:39], v2, s[44:47], s58 offen nt
  v_and_b32_dpp v16, v20, v4 row_newbcast:14 row_mask:0xf bank_mask:0xf
  v_and_b32_dpp v17, v20, v5 row_newbcast:14 row_mask:0xf bank_mask:0xf
  v_and_b32_dpp v18, v20, v6 row_newbcast:14 row_mask:0xf bank_mask:0xf
  v_and_b32_dpp v19, v20, v7 row_newbcast:14 row_mask:0xf bank_mask:0xf
  s_waitcnt vmcnt(3)
  s_nop 0
  v_mfma_f32_16x16x32_bf16 v[12:15], v[16:19], v[40:43], v[12:15]
  s_add_u32 s58, s57, 16384
  s_and_b32 s58, s58, 1048575
  buffer_load_dwordx4 v[40:43], v2, s[44:47], s58 offen nt
  v_and_b32_dpp v16, v20, v4 row_newbcast:15 row_mask:0xf bank_mask:0xf
  v_and_b32_dpp v17, v20, v5 row_newbcast:15 row_mask:0xf bank_mask:0xf
  v_and_b32_dpp v18, v20, v6 row_newbcast:15 row_mask:0xf bank_mask:0xf
  v_and_b32_dpp v19, v20, v7 row_newbcast:15 row_mask:0xf bank_mask:0xf
  s_waitcnt vmcnt(3)
  s_nop 0
  v_mfma_f32_16x16x32_bf16 v[12:15], v[16:19], v[44:47], v[12:15]
  s_add_u32 s58, s57, 24576
  s_and_b32 s58, s58, 1048575
  buffer_load_dwordx4 v[44:47], v2, s[44:47], s58 offen nt
L_v_tail:
  v_mov_b32 v28, 0
  v_mov_b32 v29, 1
  v_cmp_eq_u32 vcc, 0, v0
  s_and_saveexec_b64 s[70:71], vcc
  ds_add_u32 v28, v29 offset:4604
  s_mov_b64 exec, s[70:71]
  s_add_u32 s56, s56, 131072
  s_add_u32 s59, s59, 1
  s_cmp_lt_u32 s59, 8
  s_cbranch_scc1 L_vloop
  v_cmp_gt_u32 vcc, 32, v0
  v_add_u32 v27, 27136, v159
  v_add_u32 v25, 92672, v159
  s_nop 4
  v_mul_f32 v12, v12, v156
  v_mul_f32 v13, v13, v156
  v_mul_f32 v14, v14, v156
  v_mul_f32 v15, v15, v156
  s_and_saveexec_b64 s[70:71], vcc
  ds_write_b128 v166, v[12:15] offset:0
  s_mov_b64 exec, s[70:71]
  s_waitcnt vmcnt(0) lgkmcnt(0)
  s_barrier
  ds_read_b32 v124, v157 offset:0
  ds_read_b32 v125, v157 offset:512
  ds_read_b32 v126, v157 offset:1024
  ds_read_b32 v127, v157 offset:1536
  ds_read_b32 v128, v157 offset:2048
  ds_read_b32 v129, v157 offset:2560
  ds_read_b32 v130, v157 offset:3072
  ds_read_b32 v131, v157 offset:3584
  s_waitcnt lgkmcnt(4)
  v_add_f32 v124, v124, v125
  v_add_f32 v124, v124, v126
  v_add_f32 v124, v124, v127
  s_waitcnt lgkmcnt(0)
  v_add_f32 v124, v124, v128
  v_add_f32 v124, v124, v129
  v_add_f32 v124, v124, v130
  v_add_f32 v124, v124, v131
  v_cvt_pk_bf16_f32 v22, v124, v124
  s_nop 1
  v_and_b32_dpp v16, v22, v4 quad_perm:[0,0,0,0] row_mask:0xf bank_mask:0xf
  v_and_b32_dpp v17, v22, v5 quad_perm:[0,0,0,0] row_mask:0xf bank_mask:0xf
  v_and_b32_dpp v18, v22, v6 quad_perm:[0,0,0,0] row_mask:0xf bank_mask:0xf
  v_and_b32_dpp v19, v22, v7 quad_perm:[0,0,0,0] row_mask:0xf bank_mask:0xf
  s_nop 1
  v_mfma_f32_16x16x32_bf16 v[32:35], v[16:19], v[48:51], 0
  v_mfma_f32_16x16x32_bf16 v[36:39], v[16:19], v[52:55], 0
  v_mfma_f32_16x16x32_bf16 v[40:43], v[16:19], v[56:59], 0
  v_mfma_f32_16x16x32_bf16 v[44:47], v[16:19], v[60:63], 0
  v_and_b32_dpp v16, v22, v4 quad_perm:[1,1,1,1] row_mask:0xf bank_mask:0xf
  v_and_b32_dpp v17, v22, v5 quad_perm:[1,1,1,1] row_mask:0xf bank_mask:0xf
  v_and_b32_dpp v18, v22, v6 quad_perm:[1,1,1,1] row_mask:0xf bank_mask:0xf
  v_and_b32_dpp v19, v22, v7 quad_perm:[1,1,1,1] row_mask:0xf bank_mask:0xf
  s_nop 1
  v_mfma_f32_16x16x32_bf16 v[32:35], v[16:19], v[64:67], v[32:35]
  v_mfma_f32_16x16x32_bf16 v[36:39], v[16:19], v[68:71], v[36:39]
  v_mfma_f32_16x16x32_bf16 v[40:43], v[16:19], v[72:75], v[40:43]
  v_mfma_f32_16x16x32_bf16 v[44:47], v[16:19], v[76:79], v[44:47]
  v_and_b32_dpp v16, v22, v4 quad_perm:[2,2,2,2] row_mask:0xf bank_mask:0xf
  v_and_b32_dpp v17, v22, v5 quad_perm:[2,2,2,2] row_mask:0xf bank_mask:0xf
  v_and_b32_dpp v18, v22, v6 quad_perm:[2,2,2,2] row_mask:0xf bank_mask:0xf
  v_and_b32_dpp v19, v22, v7 quad_perm:[2,2,2,2] row_mask:0xf bank_mask:0xf
  s_nop 1
  v_mfma_f32_16x16x32_bf16 v[32:35], v[16:19], v[80:83], v[32:35]
  v_mfma_f32_16x16x32_bf16 v[36:39], v[16:19], v[84:87], v[36:39]
  v_mfma_f32_16x16x32_bf16 v[40:43], v[16:19], v[88:91], v[40:43]
  v_mfma_f32_16x16x32_bf16 v[44:47], v[16:19], v[92:95], v[44:47]
  v_and_b32_dpp v16, v22, v4 quad_perm:[3,3,3,3] row_mask:0xf bank_mask:0xf
  v_and_b32_dpp v17, v22, v5 quad_perm:[3,3,3,3] row_mask:0xf bank_mask:0xf
  v_and_b32_dpp v18, v22, v6 quad_perm:[3,3,3,3] row_mask:0xf bank_mask:0xf
  v_and_b32_dpp v19, v22, v7 quad_perm:[3,3,3,3] row_mask:0xf bank_mask:0xf
  s_nop 1
  v_mfma_f32_16x16x32_bf16 v[32:35], v[16:19], v[96:99], v[32:35]
  v_mfma_f32_16x16x32_bf16 v[36:39], v[16:19], v[100:103], v[36:39]
  v_mfma_f32_16x16x32_bf16 v[40:43], v[16:19], v[104:107], v[40:43]
  v_mfma_f32_16x16x32_bf16 v[44:47], v[16:19], v[108:111], v[44:47]
  v_cmp_gt_u32 vcc, 32, v0
  s_nop 3
  s_and_saveexec_b64 s[70:71], vcc
  ds_write_b128 v158, v[32:35] offset:0
  ds_write_b128 v158, v[36:39] offset:512
  ds_write_b128 v158, v[40:43] offset:1024
  ds_write_b128 v158, v[44:47] offset:1536
  s_mov_b64 exec, s[70:71]
  s_waitcnt lgkmcnt(0)
  s_barrier
  ds_read_b32 v124, v27 offset:0
  ds_read_b32 v125, v27 offset:16384
  ds_read_b32 v126, v27 offset:32768
  ds_read_b32 v127, v27 offset:49152
  ds_read_b32 v128, v25 offset:0
  ds_read_b32 v129, v25 offset:16384
  ds_read_b32 v130, v25 offset:32768
  ds_read_b32 v131, v25 offset:49152
  ds_read_b32 v132, v159 offset:4608
  s_waitcnt lgkmcnt(5)
  v_add_f32 v124, v124, v125
  v_add_f32 v124, v124, v126
  v_add_f32 v124, v124, v127
  s_waitcnt lgkmcnt(0)
  v_add_f32 v124, v124, v128
  v_add_f32 v124, v124, v129
  v_add_f32 v124, v124, v130
  v_add_f32 v124, v124, v131
  v_add_f32 v124, v124, v132
  v_min_u32 v124, 0xfffffffe, v124
  global_store_dword v160, v124, s[28:29] sc1
  s_branch L_fin
L_helper:
  s_setprio 1
  s_lshl_b32 s35, s30, 6
  s_add_u32 s35, s35, s33
  s_lshl_b32 s69, s35, 11
  v_lshl_add_u32 v24, v0, 4, s69
  v_mov_b32 v28, 0xffffffff
  v_mov_b32 v29, 0xffffffff
  v_mov_b32 v30, 0xffffffff
  v_mov_b32 v31, 0xffffffff
  s_lshl_b32 s35, s34, 4
  s_add_u32 s72, s35, 524288
  s_lshl_b32 s35, s32, 3
  s_add_u32 s73, s72, s35
  v_mov_b32 v26, s73
  s_lshl_b32 s35, s33, 12
  s_add_u32 s75, s35, 786432
  s_lshl_b32 s35, s30, 10
  s_add_u32 s76, s75, s35
  v_lshl_add_u32 v27, v0, 4, s76
  v_lshlrev_b32 v25, 4, v0
  s_waitcnt lgkmcnt(0)
  s_mul_i32 s68, s30, 16
  s_and_b32 s68, s68, 127
  s_mul_i32 s68, s68, 8192
  s_lshl_b32 s35, s34, 21
  s_lshl_b32 s14, s32, 20
  s_add_u32 s35, s35, s14
  s_add_u32 s36, s6, s35
  s_addc_u32 s37, s7, 0
  s_mov_b32 s38, 1048576
  s_mov_b32 s39, 0x00020000
  v_lshlrev_b32 v2, 4, v0
  v_mov_b32 v42, 0
  s_mov_b32 s59, 0
  s_mov_b32 s56, s68
  s_mov_b32 s74, 27136
L_stage:
  s_add_u32 m0, s74, 0
  s_add_u32 s58, s56, 0
  buffer_load_dwordx4 v2, s[36:39], s58 offen nt lds
  s_add_u32 m0, s74, 16384
  s_add_u32 s58, s56, 1024
  buffer_load_dwordx4 v2, s[36:39], s58 offen nt lds
  s_add_u32 m0, s74, 32768
  s_add_u32 s58, s56, 2048
  buffer_load_dwordx4 v2, s[36:39], s58 offen nt lds
  s_add_u32 m0, s74, 49152
  s_add_u32 s58, s56, 3072
  buffer_load_dwordx4 v2, s[36:39], s58 offen nt lds
  s_add_u32 m0, s74, 65536
  s_add_u32 s58, s56, 4096
  buffer_load_dwordx4 v2, s[36:39], s58 offen nt lds
  s_add_u32 m0, s74, 81920
  s_add_u32 s58, s56, 5120
  buffer_load_dwordx4 v2, s[36:39], s58 offen nt lds
  s_add_u32 m0, s74, 98304
  s_add_u32 s58, s56, 6144
  buffer_load_dwordx4 v2, s[36:39], s58 offen nt lds
  s_add_u32 m0, s74, 114688
  s_add_u32 s58, s56, 7168
  buffer_load_dwordx4 v2, s[36:39], s58 offen nt lds
  s_add_u32 s56, s56, 8192
  s_and_b32 s56, s56, 1048575
  s_add_u32 s74, s74, 1024
  s_add_u32 s59, s59, 1
  s_sub_i32 s35, s59, 3
  s_max_i32 s35, s35, 0
  v_mov_b32 v43, s35
  s_waitcnt vmcnt(24)
  ds_write_b32 v42, v43 offset:4588
  s_cmp_lt_u32 s59, 16
  s_cbranch_scc1 L_stage
  s_waitcnt vmcnt(16)
  v_mov_b32 v43, 14
  ds_write_b32 v42, v43 offset:4588
  s_waitcnt vmcnt(8)
  v_mov_b32 v43, 15
  ds_write_b32 v42, v43 offset:4588
  s_waitcnt vmcnt(0)
  v_mov_b32 v43, 16
  ds_write_b32 v42, v43 offset:4588
  s_setprio 0
  global_store_dwordx4 v24, v[28:31], s[28:29] sc1
  global_store_dwordx4 v24, v[28:31], s[28:29] offset:1024 sc1
  global_store_dwordx4 v27, v[28:31], s[28:29] sc1
  v_cmp_eq_u32 vcc, 0, v0
  s_and_saveexec_b64 s[70:71], vcc
  global_store_dwordx2 v26, v[28:29], s[28:29] sc1
  s_mov_b64 exec, s[70:71]
  s_lshl_b32 s35, s2, 6
  s_add_u32 s84, s35, 532480
  v_lshl_add_u32 v26, v0, 4, s84
  v_cmp_gt_u32 vcc, 4, v0
  s_and_saveexec_b64 s[70:71], vcc
  global_store_dwordx4 v26, v[28:31], s[28:29] sc1
  s_mov_b64 exec, s[70:71]
  global_load_dwordx4 v[48:51], v25, s[4:5] offset:0
  global_load_dwordx4 v[52:55], v25, s[4:5] offset:1024
  global_load_dwordx4 v[56:59], v25, s[4:5] offset:2048
  global_load_dwordx4 v[60:63], v25, s[4:5] offset:3072
  s_lshl_b32 s35, s30, 10
  v_add_u32 v24, s35, v25
  global_load_dwordx4 v[32:35], v24, s[4:5]
  global_load_dwordx4 v[36:39], v25, s[22:23]
  s_waitcnt vmcnt(0)
  s_lshl_b32 s35, s30, 6
  v_mov_b32 v24, s35
  v_mov_b32 v26, 1
  v_cmp_eq_u32 vcc, 0, v0
  s_and_saveexec_b64 s[70:71], vcc
  global_atomic_add v24, v26, s[26:27] sc1
  s_mov_b64 exec, s[70:71]
  ds_write_b128 v25, v[48:51] offset:6656
  ds_write_b128 v25, v[52:55] offset:7680
  ds_write_b128 v25, v[56:59] offset:8704
  ds_write_b128 v25, v[60:63] offset:9728
  v_dot2_f32_bf16 v40, v32, v36, 0
  v_dot2_f32_bf16 v40, v33, v37, v40
  v_dot2_f32_bf16 v40, v34, v38, v40
  v_dot2_f32_bf16 v40, v35, v39, v40
  s_nop 2
  s_nop 1
  v_add_f32_dpp v40, v40, v40 row_ror:8 row_mask:0xf bank_mask:0xf
  s_nop 1
  v_add_f32_dpp v40, v40, v40 row_ror:4 row_mask:0xf bank_mask:0xf
  s_nop 1
  v_add_f32_dpp v40, v40, v40 row_ror:2 row_mask:0xf bank_mask:0xf
  s_nop 1
  v_add_f32_dpp v40, v40, v40 row_ror:1 row_mask:0xf bank_mask:0xf
  v_mov_b32 v22, v40
  s_nop 1
  v_permlane16_swap_b32 v40, v22
  s_nop 0
  v_add_f32 v40, v40, v22
  v_mov_b32 v22, v40
  s_nop 1
  v_permlane32_swap_b32 v40, v22
  s_nop 0
  v_add_f32 v40, v40, v22
  v_mul_f32 v40, 0xbfb8aa3b, v40
  v_exp_f32 v40, v40
  s_nop 0
  v_add_f32 v40, 1.0, v40
  v_rcp_f32 v40, v40
  v_and_b32 v26, 15, v0
  v_cmp_gt_u32 vcc, 7, v26
  v_subrev_u32 v27, 7, v26
  v_mov_b32 v28, s18
  v_mov_b32 v29, s19
  v_mov_b32 v30, s16
  v_mov_b32 v31, s17
  v_cndmask_b32 v27, v27, v26, vcc
  v_cndmask_b32 v28, v28, v30, vcc
  v_cndmask_b32 v29, v29, v31, vcc
  v_cmp_gt_u32 vcc, 14, v26
  s_nop 1
  v_cndmask_b32 v27, 0, v27, vcc
  v_lshlrev_b32 v27, 3, v27
  s_mul_i32 s35, s33, 56
  s_mul_i32 s14, s30, 458752
  s_add_u32 s35, s35, s14
  s_mov_b32 s14, 114688
  v_mul_lo_u32 v30, v163, s14
  v_add3_u32 v27, v27, v30, s35
  v_add_co_u32 v28, vcc, v28, v27
  s_nop 1
  v_addc_co_u32 v29, vcc, 0, v29, vcc
  v_lshrrev_b32 v41, 2, v26
  v_lshlrev_b32 v41, 10, v41
  v_lshl_add_u32 v41, v163, 6, v41
  s_lshl_b32 s35, s30, 8
  v_add_u32 v41, s35, v41
  v_and_b32 v30, 1, v26
  v_cmp_eq_u32 vcc, 1, v30
  v_mov_b32 v30, 0xffff
  v_mov_b32 v31, 0xffff0000
  v_cndmask_b32 v30, v30, v31, vcc
  v_bfe_u32 v31, v26, 1, 1
  v_cmp_eq_u32 vcc, 0, v31
  s_nop 1
  v_cndmask_b32 v8, 0, v30, vcc
  v_cmp_eq_u32 vcc, 1, v31
  s_nop 1
  v_cndmask_b32 v9, 0, v30, vcc
  global_load_dwordx2 v[64:65], v[28:29], off
  global_load_dwordx2 v[66:67], v[28:29], off offset:3584
  v_add_co_u32 v28, vcc, 7168, v28
  s_nop 1
  v_addc_co_u32 v29, vcc, 0, v29, vcc
  global_load_dwordx2 v[68:69], v[28:29], off
  global_load_dwordx2 v[70:71], v[28:29], off offset:3584
  v_add_co_u32 v28, vcc, 7168, v28
  s_nop 1
  v_addc_co_u32 v29, vcc, 0, v29, vcc
  v_mov_b32 v44, 0
  v_mov_b32 v45, 0
  v_mov_b32 v46, 0
  v_mov_b32 v47, 0
  s_mov_b32 s59, 0
L_ffn:
  ds_read_b32 v42, v41 offset:6656
  v_add_u32 v41, 4, v41
  s_waitcnt vmcnt(2) lgkmcnt(0)
  v_perm_b32 v22, v42, v42, s60
  v_and_b32 v16, v22, v8
  v_and_b32 v17, v22, v9
  s_nop 1
  v_mfma_f32_16x16x16_bf16 v[44:47], v[16:17], v[64:65], v[44:47]
  v_perm_b32 v22, v42, v42, s61
  v_and_b32 v16, v22, v8
  v_and_b32 v17, v22, v9
  s_nop 1
  v_mfma_f32_16x16x16_bf16 v[44:47], v[16:17], v[66:67], v[44:47]
  global_load_dwordx2 v[64:65], v[28:29], off
  global_load_dwordx2 v[66:67], v[28:29], off offset:3584
  v_add_co_u32 v28, vcc, 7168, v28
  s_nop 1
  v_addc_co_u32 v29, vcc, 0, v29, vcc
  ds_read_b32 v42, v41 offset:6656
  v_add_u32 v41, 4, v41
  s_waitcnt vmcnt(2) lgkmcnt(0)
  v_perm_b32 v22, v42, v42, s60
  v_and_b32 v16, v22, v8
  v_and_b32 v17, v22, v9
  s_nop 1
  v_mfma_f32_16x16x16_bf16 v[44:47], v[16:17], v[68:69], v[44:47]
  v_perm_b32 v22, v42, v42, s61
  v_and_b32 v16, v22, v8
  v_and_b32 v17, v22, v9
  s_nop 1
  v_mfma_f32_16x16x16_bf16 v[44:47], v[16:17], v[70:71], v[44:47]
  global_load_dwordx2 v[68:69], v[28:29], off
  global_load_dwordx2 v[70:71], v[28:29], off offset:3584
  v_add_co_u32 v28, vcc, 7168, v28
  s_nop 1
  v_addc_co_u32 v29, vcc, 0, v29, vcc
  s_add_u32 s59, s59, 1
  s_cmp_lt_u32 s59, 7
  s_cbranch_scc1 L_ffn
  ds_read_b32 v42, v41 offset:6656
  v_add_u32 v41, 4, v41
  s_waitcnt vmcnt(2) lgkmcnt(0)
  v_perm_b32 v22, v42, v42, s60
  v_and_b32 v16, v22, v8
  v_and_b32 v17, v22, v9
  s_nop 1
  v_mfma_f32_16x16x16_bf16 v[44:47], v[16:17], v[64:65], v[44:47]
  v_perm_b32 v22, v42, v42, s61
  v_and_b32 v16, v22, v8
  v_and_b32 v17, v22, v9
  s_nop 1
  v_mfma_f32_16x16x16_bf16 v[44:47], v[16:17], v[66:67], v[44:47]
  ds_read_b32 v42, v41 offset:6656
  v_add_u32 v41, 4, v41
  s_waitcnt vmcnt(0) lgkmcnt(0)
  v_perm_b32 v22, v42, v42, s60
  v_and_b32 v16, v22, v8
  v_and_b32 v17, v22, v9
  s_nop 1
  v_mfma_f32_16x16x16_bf16 v[44:47], v[16:17], v[68:69], v[44:47]
  v_perm_b32 v22, v42, v42, s61
  v_and_b32 v16, v22, v8
  v_and_b32 v17, v22, v9
  s_nop 1
  v_mfma_f32_16x16x16_bf16 v[44:47], v[16:17], v[70:71], v[44:47]
  s_nop 7
  v_min_u32 v44, 0xfffffffe, v44
  v_min_u32 v45, 0xfffffffe, v45
  v_min_u32 v46, 0xfffffffe, v46
  v_min_u32 v47, 0xfffffffe, v47
  v_lshl_add_u32 v27, v0, 4, s76
  global_store_dwordx4 v27, v[44:47], s[28:29] sc1
L_skip_ffn1:
  v_and_b32 v24, 3, v0
  v_lshlrev_b32 v24, 6, v24
L_cnt_spin:
  global_load_dword v28, v24, s[26:27] sc1
  s_waitcnt vmcnt(0)
  v_min_u32_dpp v28, v28, v28 quad_perm:[1,0,3,2] row_mask:0xf bank_mask:0xf
  s_nop 1
  v_min_u32_dpp v28, v28, v28 quad_perm:[2,3,0,1] row_mask:0xf bank_mask:0xf
  s_nop 0
  v_readfirstlane_b32 s35, v28
  s_cmp_ge_u32 s35, 64
  s_cbranch_scc1 L_cnt_ok
  s_sleep 8
  s_sub_u32 s63, s63, 1
  s_cmp_gt_i32 s63, 0
  s_cbranch_scc1 L_cnt_spin
L_cnt_ok:
  s_xor_b32 s35, s2, 4
  s_lshl_b32 s35, s35, 6
  s_add_u32 s87, s35, 532480
  s_mov_b32 s85, 3
  s_mov_b32 s88, 0x54545454
  v_mov_b32 v24, 0
L_cn0:
  ds_read_b32 v25, v24 offset:4584
  s_waitcnt lgkmcnt(0)
  v_readfirstlane_b32 s35, v25
  s_cmp_eq_u32 s35, 8
  s_cbranch_scc1 L_cn0_ok
  s_sleep 8
  s_sub_u32 s63, s63, 1
  s_cmp_gt_i32 s63, 0
  s_cbranch_scc1 L_cn0
L_cn0_ok:
  s_mov_b32 s48, s12
  s_mov_b32 s49, s13
  s_mov_b32 s50, 4194304
  s_mov_b32 s51, 0x00020000
  v_lshlrev_b32 v25, 12, v163
  v_add_u32 v25, v25, v162
  s_lshl_b32 s56, s31, 17
  s_mov_b32 s74, 27136
  s_mov_b32 s59, 0
L_wo:
  s_mov_b32 m0, s74
  s_add_u32 s58, s56, 0
  buffer_load_dwordx4 v25, s[48:51], s58 offen  lds
  s_add_u32 s74, s74, 1024
  s_mov_b32 m0, s74
  s_add_u32 s58, s56, 256
  buffer_load_dwordx4 v25, s[48:51], s58 offen  lds
  s_add_u32 s74, s74, 1024
  s_mov_b32 m0, s74
  s_add_u32 s58, s56, 512
  buffer_load_dwordx4 v25, s[48:51], s58 offen  lds
  s_add_u32 s74, s74, 1024
  s_mov_b32 m0, s74
  s_add_u32 s58, s56, 768
  buffer_load_dwordx4 v25, s[48:51], s58 offen  lds
  s_add_u32 s74, s74, 1024
  s_waitcnt vmcnt(4)
  v_mov_b32 v1, 0
  ds_read_b32 v3, v1 offset:4604
  s_waitcnt lgkmcnt(0)
  v_readfirstlane_b32 s86, v3
  s_lshr_b32 s86, s86, 3
  s_cmp_lt_u32 s86, s85
  s_cbranch_scc1 L_ctl0
  s_add_u32 s85, s86, 3
  s_and_b32 s35, s88, 15
  s_lshr_b32 s88, s88, 4
  s_xor_b32 s35, s35, s2
  s_lshl_b32 s35, s35, 6
  s_add_u32 s87, s35, 532480
  v_mov_b32 v10, s87
  v_mov_b32 v11, s84
  v_mov_b32 v12, s86
  global_load_dword v3, v10, s[28:29] sc1
  v_cmp_eq_u32 vcc, 0, v0
  s_and_saveexec_b64 s[70:71], vcc
  global_store_dword v11, v12, s[28:29] sc1
  s_mov_b64 exec, s[70:71]
  s_waitcnt vmcnt(0)
  v_readfirstlane_b32 s35, v3
  s_add_i32 s35, s35, 0
  s_cmp_ge_i32 s35, s86
  s_cselect_b32 s35, 1, 0
  v_mov_b32 v3, s35
  ds_write_b32 v1, v3 offset:4600
L_ctl0:
  s_mov_b32 m0, s74
  s_add_u32 s58, s56, 1024
  buffer_load_dwordx4 v25, s[48:51], s58 offen  lds
  s_add_u32 s74, s74, 1024
  s_mov_b32 m0, s74
  s_add_u32 s58, s56, 1280
  buffer_load_dwordx4 v25, s[48:51], s58 offen  lds
  s_add_u32 s74, s74, 1024
  s_mov_b32 m0, s74
  s_add_u32 s58, s56, 1536
  buffer_load_dwordx4 v25, s[48:51], s58 offen  lds
  s_add_u32 s74, s74, 1024
  s_mov_b32 m0, s74
  s_add_u32 s58, s56, 1792
  buffer_load_dwordx4 v25, s[48:51], s58 offen  lds
  s_add_u32 s74, s74, 1024
  s_waitcnt vmcnt(4)
  v_mov_b32 v1, 0
  ds_read_b32 v3, v1 offset:4604
  s_waitcnt lgkmcnt(0)
  v_readfirstlane_b32 s86, v3
  s_lshr_b32 s86, s86, 3
  s_cmp_lt_u32 s86, s85
  s_cbranch_scc1 L_ctl1
  s_add_u32 s85, s86, 3
  s_and_b32 s35, s88, 15
  s_lshr_b32 s88, s88, 4
  s_xor_b32 s35, s35, s2
  s_lshl_b32 s35, s35, 6
  s_add_u32 s87, s35, 532480
  v_mov_b32 v10, s87
  v_mov_b32 v11, s84
  v_mov_b32 v12, s86
  global_load_dword v3, v10, s[28:29] sc1
  v_cmp_eq_u32 vcc, 0, v0
  s_and_saveexec_b64 s[70:71], vcc
  global_store_dword v11, v12, s[28:29] sc1
  s_mov_b64 exec, s[70:71]
  s_waitcnt vmcnt(0)
  v_readfirstlane_b32 s35, v3
  s_add_i32 s35, s35, 0
  s_cmp_ge_i32 s35, s86
  s_cselect_b32 s35, 1, 0
  v_mov_b32 v3, s35
  ds_write_b32 v1, v3 offset:4600
L_ctl1:
  s_mov_b32 m0, s74
  s_add_u32 s58, s56, 2048
  buffer_load_dwordx4 v25, s[48:51], s58 offen  lds
  s_add_u32 s74, s74, 1024
  s_mov_b32 m0, s74
  s_add_u32 s58, s56, 2304
  buffer_load_dwordx4 v25, s[48:51], s58 offen  lds
  s_add_u32 s74, s74, 1024
  s_mov_b32 m0, s74
  s_add_u32 s58, s56, 2560
  buffer_load_dwordx4 v25, s[48:51], s58 offen  lds
  s_add_u32 s74, s74, 1024
  s_mov_b32 m0, s74
  s_add_u32 s58, s56, 2816
  buffer_load_dwordx4 v25, s[48:51], s58 offen  lds
  s_add_u32 s74, s74, 1024
  s_waitcnt vmcnt(4)
  v_mov_b32 v1, 0
  ds_read_b32 v3, v1 offset:4604
  s_waitcnt lgkmcnt(0)
  v_readfirstlane_b32 s86, v3
  s_lshr_b32 s86, s86, 3
  s_cmp_lt_u32 s86, s85
  s_cbranch_scc1 L_ctl2
  s_add_u32 s85, s86, 3
  s_and_b32 s35, s88, 15
  s_lshr_b32 s88, s88, 4
  s_xor_b32 s35, s35, s2
  s_lshl_b32 s35, s35, 6
  s_add_u32 s87, s35, 532480
  v_mov_b32 v10, s87
  v_mov_b32 v11, s84
  v_mov_b32 v12, s86
  global_load_dword v3, v10, s[28:29] sc1
  v_cmp_eq_u32 vcc, 0, v0
  s_and_saveexec_b64 s[70:71], vcc
  global_store_dword v11, v12, s[28:29] sc1
  s_mov_b64 exec, s[70:71]
  s_waitcnt vmcnt(0)
  v_readfirstlane_b32 s35, v3
  s_add_i32 s35, s35, 0
  s_cmp_ge_i32 s35, s86
  s_cselect_b32 s35, 1, 0
  v_mov_b32 v3, s35
  ds_write_b32 v1, v3 offset:4600
L_ctl2:
  s_mov_b32 m0, s74
  s_add_u32 s58, s56, 3072
  buffer_load_dwordx4 v25, s[48:51], s58 offen  lds
  s_add_u32 s74, s74, 1024
  s_mov_b32 m0, s74
  s_add_u32 s58, s56, 3328
  buffer_load_dwordx4 v25, s[48:51], s58 offen  lds
  s_add_u32 s74, s74, 1024
  s_mov_b32 m0, s74
  s_add_u32 s58, s56, 3584
  buffer_load_dwordx4 v25, s[48:51], s58 offen  lds
  s_add_u32 s74, s74, 1024
  s_mov_b32 m0, s74
  s_add_u32 s58, s56, 3840
  buffer_load_dwordx4 v25, s[48:51], s58 offen  lds
  s_add_u32 s74, s74, 1024
  s_waitcnt vmcnt(4)
  v_mov_b32 v1, 0
  ds_read_b32 v3, v1 offset:4604
  s_waitcnt lgkmcnt(0)
  v_readfirstlane_b32 s86, v3
  s_lshr_b32 s86, s86, 3
  s_cmp_lt_u32 s86, s85
  s_cbranch_scc1 L_ctl3
  s_add_u32 s85, s86, 3
  s_and_b32 s35, s88, 15
  s_lshr_b32 s88, s88, 4
  s_xor_b32 s35, s35, s2
  s_lshl_b32 s35, s35, 6
  s_add_u32 s87, s35, 532480
  v_mov_b32 v10, s87
  v_mov_b32 v11, s84
  v_mov_b32 v12, s86
  global_load_dword v3, v10, s[28:29] sc1
  v_cmp_eq_u32 vcc, 0, v0
  s_and_saveexec_b64 s[70:71], vcc
  global_store_dword v11, v12, s[28:29] sc1
  s_mov_b64 exec, s[70:71]
  s_waitcnt vmcnt(0)
  v_readfirstlane_b32 s35, v3
  s_add_i32 s35, s35, 0
  s_cmp_ge_i32 s35, s86
  s_cselect_b32 s35, 1, 0
  v_mov_b32 v3, s35
  ds_write_b32 v1, v3 offset:4600
L_ctl3:
  s_add_u32 s56, s56, 16384
  s_add_u32 s59, s59, 1
  s_cmp_lt_u32 s59, 8
  s_cbranch_scc1 L_wo
L_skip_wo:
  s_waitcnt vmcnt(0)
  v_mov_b32 v24, 0
  v_mov_b32 v25, 1
  v_cmp_eq_u32 vcc, 0, v0
  s_and_saveexec_b64 s[70:71], vcc
  ds_write_b32 v24, v25 offset:4580
  s_mov_b64 exec, s[70:71]
  s_mov_b32 s52, s20
  s_mov_b32 s53, s21
  s_mov_b32 s54, 1835008
  s_mov_b32 s55, 0x00020000
  s_mul_i32 s35, s33, 28
  v_add_u32 v25, s35, v163
  v_lshl_add_u32 v25, v25, 10, v162
  v_lshlrev_b32 v24, 10, v163
  v_add_u32 v24, v24, v162
  s_lshl_b32 s35, s30, 8
  s_add_u32 s35, s35, s75
  v_add_u32 v24, s35, v24
L_fp_spin:
  global_load_dwordx4 v[44:47], v24, s[28:29] sc1
  s_waitcnt vmcnt(0)
  v_cmp_eq_u32 vcc, -1, v44
  v_cmp_eq_u32 s[70:71], -1, v45
  s_nop 1
  s_or_b64 vcc, vcc, s[70:71]
  v_cmp_eq_u32 s[70:71], -1, v46
  s_nop 1
  s_or_b64 vcc, vcc, s[70:71]
  v_cmp_eq_u32 s[70:71], -1, v47
  s_nop 1
  s_or_b64 vcc, vcc, s[70:71]
  s_cbranch_vccz L_fp_ok
  s_sleep 8
  s_sub_u32 s63, s63, 1
  s_cmp_gt_i32 s63, 0
  s_cbranch_scc1 L_fp_spin
L_fp_ok:
  s_mov_b32 s58, 0
  buffer_load_dwordx4 v[48:51], v25, s[52:55], s58 offen offset:0
  buffer_load_dwordx4 v[52:55], v25, s[52:55], s58 offen offset:256
  buffer_load_dwordx4 v[56:59], v25, s[52:55], s58 offen offset:512
  buffer_load_dwordx4 v[60:63], v25, s[52:55], s58 offen offset:768
  s_waitcnt vmcnt(4)
  v_mov_b32 v1, 0
  ds_read_b32 v3, v1 offset:4604
  s_waitcnt lgkmcnt(0)
  v_readfirstlane_b32 s86, v3
  s_lshr_b32 s86, s86, 3
  s_cmp_lt_u32 s86, s85
  s_cbranch_scc1 L_ctl4
  s_add_u32 s85, s86, 3
  s_and_b32 s35, s88, 15
  s_lshr_b32 s88, s88, 4
  s_xor_b32 s35, s35, s2
  s_lshl_b32 s35, s35, 6
  s_add_u32 s87, s35, 532480
  v_mov_b32 v10, s87
  v_mov_b32 v11, s84
  v_mov_b32 v12, s86
  global_load_dword v3, v10, s[28:29] sc1
  v_cmp_eq_u32 vcc, 0, v0
  s_and_saveexec_b64 s[70:71], vcc
  global_store_dword v11, v12, s[28:29] sc1
  s_mov_b64 exec, s[70:71]
  s_waitcnt vmcnt(0)
  v_readfirstlane_b32 s35, v3
  s_add_i32 s35, s35, 0
  s_cmp_ge_i32 s35, s86
  s_cselect_b32 s35, 1, 0
  v_mov_b32 v3, s35
  ds_write_b32 v1, v3 offset:4600
L_ctl4:
  s_mov_b32 s58, 4096
  buffer_load_dwordx4 v[64:67], v25, s[52:55], s58 offen offset:0
  buffer_load_dwordx4 v[68:71], v25, s[52:55], s58 offen offset:256
  buffer_load_dwordx4 v[72:75], v25, s[52:55], s58 offen offset:512
  buffer_load_dwordx4 v[76:79], v25, s[52:55], s58 offen offset:768
  s_waitcnt vmcnt(4)
  v_mov_b32 v1, 0
  ds_read_b32 v3, v1 offset:4604
  s_waitcnt lgkmcnt(0)
  v_readfirstlane_b32 s86, v3
  s_lshr_b32 s86, s86, 3
  s_cmp_lt_u32 s86, s85
  s_cbranch_scc1 L_ctl5
  s_add_u32 s85, s86, 3
  s_and_b32 s35, s88, 15
  s_lshr_b32 s88, s88, 4
  s_xor_b32 s35, s35, s2
  s_lshl_b32 s35, s35, 6
  s_add_u32 s87, s35, 532480
  v_mov_b32 v10, s87
  v_mov_b32 v11, s84
  v_mov_b32 v12, s86
  global_load_dword v3, v10, s[28:29] sc1
  v_cmp_eq_u32 vcc, 0, v0
  s_and_saveexec_b64 s[70:71], vcc
  global_store_dword v11, v12, s[28:29] sc1
  s_mov_b64 exec, s[70:71]
  s_waitcnt vmcnt(0)
  v_readfirstlane_b32 s35, v3
  s_add_i32 s35, s35, 0
  s_cmp_ge_i32 s35, s86
  s_cselect_b32 s35, 1, 0
  v_mov_b32 v3, s35
  ds_write_b32 v1, v3 offset:4600
L_ctl5:
  s_mov_b32 s58, 8192
  buffer_load_dwordx4 v[80:83], v25, s[52:55], s58 offen offset:0
  buffer_load_dwordx4 v[84:87], v25, s[52:55], s58 offen offset:256
  buffer_load_dwordx4 v[88:91], v25, s[52:55], s58 offen offset:512
  buffer_load_dwordx4 v[92:95], v25, s[52:55], s58 offen offset:768
  s_waitcnt vmcnt(4)
  v_mov_b32 v1, 0
  ds_read_b32 v3, v1 offset:4604
  s_waitcnt lgkmcnt(0)
  v_readfirstlane_b32 s86, v3
  s_lshr_b32 s86, s86, 3
  s_cmp_lt_u32 s86, s85
  s_cbranch_scc1 L_ctl6
  s_add_u32 s85, s86, 3
  s_and_b32 s35, s88, 15
  s_lshr_b32 s88, s88, 4
  s_xor_b32 s35, s35, s2
  s_lshl_b32 s35, s35, 6
  s_add_u32 s87, s35, 532480
  v_mov_b32 v10, s87
  v_mov_b32 v11, s84
  v_mov_b32 v12, s86
  global_load_dword v3, v10, s[28:29] sc1
  v_cmp_eq_u32 vcc, 0, v0
  s_and_saveexec_b64 s[70:71], vcc
  global_store_dword v11, v12, s[28:29] sc1
  s_mov_b64 exec, s[70:71]
  s_waitcnt vmcnt(0)
  v_readfirstlane_b32 s35, v3
  s_add_i32 s35, s35, 0
  s_cmp_ge_i32 s35, s86
  s_cselect_b32 s35, 1, 0
  v_mov_b32 v3, s35
  ds_write_b32 v1, v3 offset:4600
L_ctl6:
  s_mov_b32 s58, 12288
  buffer_load_dwordx4 v[96:99], v25, s[52:55], s58 offen offset:0
  buffer_load_dwordx4 v[100:103], v25, s[52:55], s58 offen offset:256
  buffer_load_dwordx4 v[104:107], v25, s[52:55], s58 offen offset:512
  buffer_load_dwordx4 v[108:111], v25, s[52:55], s58 offen offset:768
  s_waitcnt vmcnt(4)
  v_mov_b32 v1, 0
  ds_read_b32 v3, v1 offset:4604
  s_waitcnt lgkmcnt(0)
  v_readfirstlane_b32 s86, v3
  s_lshr_b32 s86, s86, 3
  s_cmp_lt_u32 s86, s85
  s_cbranch_scc1 L_ctl7
  s_add_u32 s85, s86, 3
  s_and_b32 s35, s88, 15
  s_lshr_b32 s88, s88, 4
  s_xor_b32 s35, s35, s2
  s_lshl_b32 s35, s35, 6
  s_add_u32 s87, s35, 532480
  v_mov_b32 v10, s87
  v_mov_b32 v11, s84
  v_mov_b32 v12, s86
  global_load_dword v3, v10, s[28:29] sc1
  v_cmp_eq_u32 vcc, 0, v0
  s_and_saveexec_b64 s[70:71], vcc
  global_store_dword v11, v12, s[28:29] sc1
  s_mov_b64 exec, s[70:71]
  s_waitcnt vmcnt(0)
  v_readfirstlane_b32 s35, v3
  s_add_i32 s35, s35, 0
  s_cmp_ge_i32 s35, s86
  s_cselect_b32 s35, 1, 0
  v_mov_b32 v3, s35
  ds_write_b32 v1, v3 offset:4600
L_ctl7:
  s_mov_b32 s58, 16384
  buffer_load_dwordx4 v[112:115], v25, s[52:55], s58 offen offset:0
  buffer_load_dwordx4 v[116:119], v25, s[52:55], s58 offen offset:256
  buffer_load_dwordx4 v[120:123], v25, s[52:55], s58 offen offset:512
  buffer_load_dwordx4 v[124:127], v25, s[52:55], s58 offen offset:768
  s_waitcnt vmcnt(4)
  v_mov_b32 v1, 0
  ds_read_b32 v3, v1 offset:4604
  s_waitcnt lgkmcnt(0)
  v_readfirstlane_b32 s86, v3
  s_lshr_b32 s86, s86, 3
  s_cmp_lt_u32 s86, s85
  s_cbranch_scc1 L_ctl8
  s_add_u32 s85, s86, 3
  s_and_b32 s35, s88, 15
  s_lshr_b32 s88, s88, 4
  s_xor_b32 s35, s35, s2
  s_lshl_b32 s35, s35, 6
  s_add_u32 s87, s35, 532480
  v_mov_b32 v10, s87
  v_mov_b32 v11, s84
  v_mov_b32 v12, s86
  global_load_dword v3, v10, s[28:29] sc1
  v_cmp_eq_u32 vcc, 0, v0
  s_and_saveexec_b64 s[70:71], vcc
  global_store_dword v11, v12, s[28:29] sc1
  s_mov_b64 exec, s[70:71]
  s_waitcnt vmcnt(0)
  v_readfirstlane_b32 s35, v3
  s_add_i32 s35, s35, 0
  s_cmp_ge_i32 s35, s86
  s_cselect_b32 s35, 1, 0
  v_mov_b32 v3, s35
  ds_write_b32 v1, v3 offset:4600
L_ctl8:
  s_mov_b32 s58, 20480
  buffer_load_dwordx4 v[128:131], v25, s[52:55], s58 offen offset:0
  buffer_load_dwordx4 v[132:135], v25, s[52:55], s58 offen offset:256
  buffer_load_dwordx4 v[136:139], v25, s[52:55], s58 offen offset:512
  buffer_load_dwordx4 v[140:143], v25, s[52:55], s58 offen offset:768
  s_waitcnt vmcnt(4)
  v_mov_b32 v1, 0
  ds_read_b32 v3, v1 offset:4604
  s_waitcnt lgkmcnt(0)
  v_readfirstlane_b32 s86, v3
  s_lshr_b32 s86, s86, 3
  s_cmp_lt_u32 s86, s85
  s_cbranch_scc1 L_ctl9
  s_add_u32 s85, s86, 3
  s_and_b32 s35, s88, 15
  s_lshr_b32 s88, s88, 4
  s_xor_b32 s35, s35, s2
  s_lshl_b32 s35, s35, 6
  s_add_u32 s87, s35, 532480
  v_mov_b32 v10, s87
  v_mov_b32 v11, s84
  v_mov_b32 v12, s86
  global_load_dword v3, v10, s[28:29] sc1
  v_cmp_eq_u32 vcc, 0, v0
  s_and_saveexec_b64 s[70:71], vcc
  global_store_dword v11, v12, s[28:29] sc1
  s_mov_b64 exec, s[70:71]
  s_waitcnt vmcnt(0)
  v_readfirstlane_b32 s35, v3
  s_add_i32 s35, s35, 0
  s_cmp_ge_i32 s35, s86
  s_cselect_b32 s35, 1, 0
  v_mov_b32 v3, s35
  ds_write_b32 v1, v3 offset:4600
L_ctl9:
  s_mov_b32 s58, 24576
  buffer_load_dwordx4 v[144:147], v25, s[52:55], s58 offen offset:0
  buffer_load_dwordx4 v[148:151], v25, s[52:55], s58 offen offset:256
  buffer_load_dwordx4 v[152:155], v25, s[52:55], s58 offen offset:512
  buffer_load_dwordx4 v[156:159], v25, s[52:55], s58 offen offset:768
  s_waitcnt vmcnt(4)
  v_mov_b32 v1, 0
  ds_read_b32 v3, v1 offset:4604
  s_waitcnt lgkmcnt(0)
  v_readfirstlane_b32 s86, v3
  s_lshr_b32 s86, s86, 3
  s_cmp_lt_u32 s86, s85
  s_cbranch_scc1 L_ctl10
  s_add_u32 s85, s86, 3
  s_and_b32 s35, s88, 15
  s_lshr_b32 s88, s88, 4
  s_xor_b32 s35, s35, s2
  s_lshl_b32 s35, s35, 6
  s_add_u32 s87, s35, 532480
  v_mov_b32 v10, s87
  v_mov_b32 v11, s84
  v_mov_b32 v12, s86
  global_load_dword v3, v10, s[28:29] sc1
  v_cmp_eq_u32 vcc, 0, v0
  s_and_saveexec_b64 s[70:71], vcc
  global_store_dword v11, v12, s[28:29] sc1
  s_mov_b64 exec, s[70:71]
  s_waitcnt vmcnt(0)
  v_readfirstlane_b32 s35, v3
  s_add_i32 s35, s35, 0
  s_cmp_ge_i32 s35, s86
  s_cselect_b32 s35, 1, 0
  v_mov_b32 v3, s35
  ds_write_b32 v1, v3 offset:4600
L_ctl10:
  v_mov_b32 v32, v44
  v_mov_b32 v33, v45
  v_mov_b32 v34, v46
  v_mov_b32 v35, v47
  s_nop 1
  v_permlane16_swap_b32 v44, v32
  v_permlane16_swap_b32 v45, v33
  v_permlane16_swap_b32 v46, v34
  v_permlane16_swap_b32 v47, v35
  s_nop 0
  v_add_f32 v44, v44, v32
  v_add_f32 v45, v45, v33
  v_add_f32 v46, v46, v34
  v_add_f32 v47, v47, v35
  v_mov_b32 v32, v44
  v_mov_b32 v33, v45
  v_mov_b32 v34, v46
  v_mov_b32 v35, v47
  s_nop 1
  v_permlane32_swap_b32 v44, v32
  v_permlane32_swap_b32 v45, v33
  v_permlane32_swap_b32 v46, v34
  v_permlane32_swap_b32 v47, v35
  s_nop 0
  v_add_f32 v44, v44, v32
  v_add_f32 v45, v45, v33
  v_add_f32 v46, v46, v34
  v_add_f32 v47, v47, v35
  s_nop 1
  v_mov_b32_dpp v32, v44 row_shl:7 row_mask:0xf bank_mask:0xf
  v_mov_b32_dpp v33, v45 row_shl:7 row_mask:0xf bank_mask:0xf
  v_mov_b32_dpp v34, v46 row_shl:7 row_mask:0xf bank_mask:0xf
  v_mov_b32_dpp v35, v47 row_shl:7 row_mask:0xf bank_mask:0xf
  v_mul_f32 v36, v44, v44
  v_mov_b32 v26, 0x3d372713
  v_fma_f32 v36, v36, v26, 1.0
  v_mul_f32 v36, v36, v44
  v_mul_f32 v36, 0xc0135761, v36
  v_exp_f32 v36, v36
  s_nop 0
  v_add_f32 v36, 1.0, v36
  v_rcp_f32 v36, v36
  s_nop 0
  v_mul_f32 v36, v36, v44
  v_mul_f32 v36, v36, v32
  v_mul_f32 v37, v45, v45
  v_mov_b32 v26, 0x3d372713
  v_fma_f32 v37, v37, v26, 1.0
  v_mul_f32 v37, v37, v45
  v_mul_f32 v37, 0xc0135761, v37
  v_exp_f32 v37, v37
  s_nop 0
  v_add_f32 v37, 1.0, v37
  v_rcp_f32 v37, v37
  s_nop 0
  v_mul_f32 v37, v37, v45
  v_mul_f32 v37, v37, v33
  v_mul_f32 v38, v46, v46
  v_mov_b32 v26, 0x3d372713
  v_fma_f32 v38, v38, v26, 1.0
  v_mul_f32 v38, v38, v46
  v_mul_f32 v38, 0xc0135761, v38
  v_exp_f32 v38, v38
  s_nop 0
  v_add_f32 v38, 1.0, v38
  v_rcp_f32 v38, v38
  s_nop 0
  v_mul_f32 v38, v38, v46
  v_mul_f32 v38, v38, v34
  v_mul_f32 v39, v47, v47
  v_mov_b32 v26, 0x3d372713
  v_fma_f32 v39, v39, v26, 1.0
  v_mul_f32 v39, v39, v47
  v_mul_f32 v39, 0xc0135761, v39
  v_exp_f32 v39, v39
  s_nop 0
  v_add_f32 v39, 1.0, v39
  v_rcp_f32 v39, v39
  s_nop 0
  v_mul_f32 v39, v39, v47
  v_mul_f32 v39, v39, v35
  v_sub_f32 v26, 1.0, v40
  v_cmp_gt_u32 vcc, 7, v0
  v_mul_f32 v36, v36, v26
  v_mul_f32 v37, v37, v26
  v_mul_f32 v38, v38, v26
  v_mul_f32 v39, v39, v26
  v_cndmask_b32 v36, 0, v36, vcc
  v_cndmask_b32 v37, 0, v37, vcc
  v_cndmask_b32 v38, 0, v38, vcc
  v_cndmask_b32 v39, 0, v39, vcc
  v_lshlrev_b32 v26, 4, v0
  v_cmp_gt_u32 vcc, 8, v0
  s_and_saveexec_b64 s[70:71], vcc
  ds_write_b128 v26, v[36:39] offset:4352
  s_mov_b64 exec, s[70:71]
  v_lshlrev_b32 v27, 2, v163
  s_waitcnt lgkmcnt(0)
  ds_read_b32 v32, v27 offset:4352
  ds_read_b32 v33, v27 offset:4368
  ds_read_b32 v34, v27 offset:4384
  ds_read_b32 v35, v27 offset:4400
  ds_read_b32 v36, v27 offset:4416
  ds_read_b32 v37, v27 offset:4432
  ds_read_b32 v38, v27 offset:4448
  s_waitcnt lgkmcnt(0)
  v_cvt_pk_bf16_f32 v41, v32, v32
  v_and_b32 v16, v41, v4
  v_and_b32 v17, v41, v5
  v_and_b32 v18, v41, v6
  v_and_b32 v19, v41, v7
  s_waitcnt vmcnt(24)
  s_nop 0
  v_mfma_f32_16x16x32_bf16 v[20:23], v[16:19], v[48:51], 0
  v_mfma_f32_16x16x32_bf16 v[24:27], v[16:19], v[52:55], 0
  v_mfma_f32_16x16x32_bf16 v[28:31], v[16:19], v[56:59], 0
  v_mfma_f32_16x16x32_bf16 v[44:47], v[16:19], v[60:63], 0
  v_cvt_pk_bf16_f32 v41, v33, v33
  v_and_b32 v16, v41, v4
  v_and_b32 v17, v41, v5
  v_and_b32 v18, v41, v6
  v_and_b32 v19, v41, v7
  s_waitcnt vmcnt(20)
  s_nop 0
  v_mfma_f32_16x16x32_bf16 v[20:23], v[16:19], v[64:67], v[20:23]
  v_mfma_f32_16x16x32_bf16 v[24:27], v[16:19], v[68:71], v[24:27]
  v_mfma_f32_16x16x32_bf16 v[28:31], v[16:19], v[72:75], v[28:31]
  v_mfma_f32_16x16x32_bf16 v[44:47], v[16:19], v[76:79], v[44:47]
  v_cvt_pk_bf16_f32 v41, v34, v34
  v_and_b32 v16, v41, v4
  v_and_b32 v17, v41, v5
  v_and_b32 v18, v41, v6
  v_and_b32 v19, v41, v7
  s_waitcnt vmcnt(16)
  s_nop 0
  v_mfma_f32_16x16x32_bf16 v[20:23], v[16:19], v[80:83], v[20:23]
  v_mfma_f32_16x16x32_bf16 v[24:27], v[16:19], v[84:87], v[24:27]
  v_mfma_f32_16x16x32_bf16 v[28:31], v[16:19], v[88:91], v[28:31]
  v_mfma_f32_16x16x32_bf16 v[44:47], v[16:19], v[92:95], v[44:47]
  v_cvt_pk_bf16_f32 v41, v35, v35
  v_and_b32 v16, v41, v4
  v_and_b32 v17, v41, v5
  v_and_b32 v18, v41, v6
  v_and_b32 v19, v41, v7
  s_waitcnt vmcnt(12)
  s_nop 0
  v_mfma_f32_16x16x32_bf16 v[20:23], v[16:19], v[96:99], v[20:23]
  v_mfma_f32_16x16x32_bf16 v[24:27], v[16:19], v[100:103], v[24:27]
  v_mfma_f32_16x16x32_bf16 v[28:31], v[16:19], v[104:107], v[28:31]
  v_mfma_f32_16x16x32_bf16 v[44:47], v[16:19], v[108:111], v[44:47]
  v_cvt_pk_bf16_f32 v41, v36, v36
  v_and_b32 v16, v41, v4
  v_and_b32 v17, v41, v5
  v_and_b32 v18, v41, v6
  v_and_b32 v19, v41, v7
  s_waitcnt vmcnt(8)
  s_nop 0
  v_mfma_f32_16x16x32_bf16 v[20:23], v[16:19], v[112:115], v[20:23]
  v_mfma_f32_16x16x32_bf16 v[24:27], v[16:19], v[116:119], v[24:27]
  v_mfma_f32_16x16x32_bf16 v[28:31], v[16:19], v[120:123], v[28:31]
  v_mfma_f32_16x16x32_bf16 v[44:47], v[16:19], v[124:127], v[44:47]
  v_cvt_pk_bf16_f32 v41, v37, v37
  v_and_b32 v16, v41, v4
  v_and_b32 v17, v41, v5
  v_and_b32 v18, v41, v6
  v_and_b32 v19, v41, v7
  s_waitcnt vmcnt(4)
  s_nop 0
  v_mfma_f32_16x16x32_bf16 v[20:23], v[16:19], v[128:131], v[20:23]
  v_mfma_f32_16x16x32_bf16 v[24:27], v[16:19], v[132:135], v[24:27]
  v_mfma_f32_16x16x32_bf16 v[28:31], v[16:19], v[136:139], v[28:31]
  v_mfma_f32_16x16x32_bf16 v[44:47], v[16:19], v[140:143], v[44:47]
  v_cvt_pk_bf16_f32 v41, v38, v38
  v_and_b32 v16, v41, v4
  v_and_b32 v17, v41, v5
  v_and_b32 v18, v41, v6
  v_and_b32 v19, v41, v7
  s_waitcnt vmcnt(0)
  s_nop 0
  v_mfma_f32_16x16x32_bf16 v[20:23], v[16:19], v[144:147], v[20:23]
  v_mfma_f32_16x16x32_bf16 v[24:27], v[16:19], v[148:151], v[24:27]
  v_mfma_f32_16x16x32_bf16 v[28:31], v[16:19], v[152:155], v[28:31]
  v_mfma_f32_16x16x32_bf16 v[44:47], v[16:19], v[156:159], v[44:47]
  v_and_b32 v42, 15, v0
  v_lshlrev_b32 v42, 5, v42
  v_lshl_add_u32 v42, v163, 4, v42
  v_cmp_gt_u32 vcc, 32, v0
  s_nop 5
  s_and_saveexec_b64 s[70:71], vcc
  ds_write_b128 v42, v[20:23] offset:4608
  ds_write_b128 v42, v[24:27] offset:5120
  ds_write_b128 v42, v[28:31] offset:5632
  ds_write_b128 v42, v[44:47] offset:6144
  s_mov_b64 exec, s[70:71]
L_skip_ffn:
  v_mov_b32 v24, 0
L_cnt8:
  ds_read_b32 v25, v24 offset:4576
  s_waitcnt lgkmcnt(0)
  v_readfirstlane_b32 s35, v25
  s_cmp_eq_u32 s35, 8
  s_cbranch_scc1 L_cnt8_ok
  v_mov_b32 v1, 0
  ds_read_b32 v3, v1 offset:4604
  s_waitcnt lgkmcnt(0)
  v_readfirstlane_b32 s86, v3
  s_lshr_b32 s86, s86, 3
  s_cmp_lt_u32 s86, s85
  s_cbranch_scc1 L_ctl11
  s_add_u32 s85, s86, 3
  s_and_b32 s35, s88, 15
  s_lshr_b32 s88, s88, 4
  s_xor_b32 s35, s35, s2
  s_lshl_b32 s35, s35, 6
  s_add_u32 s87, s35, 532480
  v_mov_b32 v10, s87
  v_mov_b32 v11, s84
  v_mov_b32 v12, s86
  global_load_dword v3, v10, s[28:29] sc1
  v_cmp_eq_u32 vcc, 0, v0
  s_and_saveexec_b64 s[70:71], vcc
  global_store_dword v11, v12, s[28:29] sc1
  s_mov_b64 exec, s[70:71]
  s_waitcnt vmcnt(0)
  v_readfirstlane_b32 s35, v3
  s_add_i32 s35, s35, 0
  s_cmp_ge_i32 s35, s86
  s_cselect_b32 s35, 1, 0
  v_mov_b32 v3, s35
  ds_write_b32 v1, v3 offset:4600
L_ctl11:
  s_sleep 4
  s_sub_u32 s63, s63, 1
  s_cmp_gt_i32 s63, 0
  s_cbranch_scc1 L_cnt8
L_cnt8_ok:
  v_and_b32 v24, 7, v0
  v_lshlrev_b32 v24, 3, v24
  ds_read_b64 v[26:27], v24 offset:4512
  s_waitcnt lgkmcnt(0)
  v_mov_b32 v28, v26
  s_nop 1
  v_max_f32_dpp v28, v28, v28 row_ror:4 row_mask:0xf bank_mask:0xf
  s_nop 1
  v_max_f32_dpp v28, v28, v28 row_ror:2 row_mask:0xf bank_mask:0xf
  s_nop 1
  v_max_f32_dpp v28, v28, v28 row_ror:1 row_mask:0xf bank_mask:0xf
  v_sub_f32 v29, v26, v28
  v_exp_f32 v29, v29
  s_nop 0
  v_mul_f32 v29, v29, v27
  s_nop 1
  v_add_f32_dpp v29, v29, v29 row_ror:4 row_mask:0xf bank_mask:0xf
  s_nop 1
  v_add_f32_dpp v29, v29, v29 row_ror:2 row_mask:0xf bank_mask:0xf
  s_nop 1
  v_add_f32_dpp v29, v29, v29 row_ror:1 row_mask:0xf bank_mask:0xf
  v_min_u32 v28, 0xfffffffe, v28
  v_min_u32 v29, 0xfffffffe, v29
  v_mov_b32 v24, s73
  v_cmp_eq_u32 vcc, 0, v0
  s_and_saveexec_b64 s[70:71], vcc
  global_store_dwordx2 v24, v[28:29], s[28:29] sc1
  s_mov_b64 exec, s[70:71]
  s_xor_b32 s35, s73, 8
  v_mov_b32 v24, s35
L_ml_spin:
  global_load_dwordx2 v[30:31], v24, s[28:29] sc1
  s_waitcnt vmcnt(0)
  v_cmp_eq_u32 vcc, -1, v30
  v_cmp_eq_u32 s[70:71], -1, v31
  s_nop 1
  s_or_b64 vcc, vcc, s[70:71]
  s_cbranch_vccz L_ml_ok
  v_mov_b32 v1, 0
  ds_read_b32 v3, v1 offset:4604
  s_waitcnt lgkmcnt(0)
  v_readfirstlane_b32 s86, v3
  s_lshr_b32 s86, s86, 3
  s_cmp_lt_u32 s86, s85
  s_cbranch_scc1 L_ctl12
  s_add_u32 s85, s86, 3
  s_and_b32 s35, s88, 15
  s_lshr_b32 s88, s88, 4
  s_xor_b32 s35, s35, s2
  s_lshl_b32 s35, s35, 6
  s_add_u32 s87, s35, 532480
  v_mov_b32 v10, s87
  v_mov_b32 v11, s84
  v_mov_b32 v12, s86
  global_load_dword v3, v10, s[28:29] sc1
  v_cmp_eq_u32 vcc, 0, v0
  s_and_saveexec_b64 s[70:71], vcc
  global_store_dword v11, v12, s[28:29] sc1
  s_mov_b64 exec, s[70:71]
  s_waitcnt vmcnt(0)
  v_readfirstlane_b32 s35, v3
  s_add_i32 s35, s35, 0
  s_cmp_ge_i32 s35, s86
  s_cselect_b32 s35, 1, 0
  v_mov_b32 v3, s35
  ds_write_b32 v1, v3 offset:4600
L_ctl12:
  s_sleep 8
  s_sub_u32 s63, s63, 1
  s_cmp_gt_i32 s63, 0
  s_cbranch_scc1 L_ml_spin
L_ml_ok:
  v_max_f32 v32, v28, v30
  v_sub_f32 v33, v28, v32
  v_sub_f32 v34, v30, v32
  v_sub_f32 v35, v26, v32
  v_exp_f32 v33, v33
  v_exp_f32 v34, v34
  v_exp_f32 v35, v35
  s_nop 0
  v_mul_f32 v33, v33, v29
  v_fmac_f32 v33, v34, v31
  v_rcp_f32 v33, v33
  s_nop 0
  v_mul_f32 v35, v35, v33
  v_mul_f32 v35, v35, v40
  v_lshlrev_b32 v24, 2, v0
  v_cmp_gt_u32 vcc, 8, v0
  s_and_saveexec_b64 s[70:71], vcc
  ds_write_b32 v24, v35 offset:4480
  s_mov_b64 exec, s[70:71]
  v_mov_b32 v24, 0
  v_mov_b32 v25, 2
  v_cmp_eq_u32 vcc, 0, v0
  s_and_saveexec_b64 s[70:71], vcc
  ds_write_b32 v24, v25 offset:4580
  s_mov_b64 exec, s[70:71]
  s_waitcnt lgkmcnt(0)
L_ctl_loop:
  v_mov_b32 v1, 0
  ds_read_b32 v3, v1 offset:4604
  s_waitcnt lgkmcnt(0)
  v_readfirstlane_b32 s86, v3
  s_lshr_b32 s86, s86, 3
  s_cmp_lt_u32 s86, s85
  s_cbranch_scc1 L_ctl13
  s_add_u32 s85, s86, 3
  s_and_b32 s35, s88, 15
  s_lshr_b32 s88, s88, 4
  s_xor_b32 s35, s35, s2
  s_lshl_b32 s35, s35, 6
  s_add_u32 s87, s35, 532480
  v_mov_b32 v10, s87
  v_mov_b32 v11, s84
  v_mov_b32 v12, s86
  global_load_dword v3, v10, s[28:29] sc1
  v_cmp_eq_u32 vcc, 0, v0
  s_and_saveexec_b64 s[70:71], vcc
  global_store_dword v11, v12, s[28:29] sc1
  s_mov_b64 exec, s[70:71]
  s_waitcnt vmcnt(0)
  v_readfirstlane_b32 s35, v3
  s_add_i32 s35, s35, 0
  s_cmp_ge_i32 s35, s86
  s_cselect_b32 s35, 1, 0
  v_mov_b32 v3, s35
  ds_write_b32 v1, v3 offset:4600
L_ctl13:
  s_cmp_ge_u32 s85, 14
  s_cbranch_scc1 L_ctl_done
  s_sleep 4
  s_sub_u32 s63, s63, 1
  s_cmp_gt_i32 s63, 0
  s_cbranch_scc1 L_ctl_loop
L_ctl_done:
  s_barrier
  s_mov_b32 s48, s28
  s_mov_b32 s49, s29
  s_mov_b32 s50, 524288
  s_mov_b32 s51, 0x00020000
  v_lshrrev_b32 v24, 3, v0
  v_lshlrev_b32 v24, 11, v24
  v_and_b32 v25, 7, v0
  v_lshl_add_u32 v24, v25, 2, v24
  s_lshl_b32 s35, s30, 17
  s_lshl_b32 s14, s33, 5
  s_add_u32 s35, s35, s14
  s_barrier
L_y_spin:
  s_add_u32 s58, s35, 0
  buffer_load_dword v32, v24, s[48:51], s58 offen sc1
  s_add_u32 s58, s35, 16384
  buffer_load_dword v33, v24, s[48:51], s58 offen sc1
  s_add_u32 s58, s35, 32768
  buffer_load_dword v34, v24, s[48:51], s58 offen sc1
  s_add_u32 s58, s35, 49152
  buffer_load_dword v35, v24, s[48:51], s58 offen sc1
  s_add_u32 s58, s35, 65536
  buffer_load_dword v36, v24, s[48:51], s58 offen sc1
  s_add_u32 s58, s35, 81920
  buffer_load_dword v37, v24, s[48:51], s58 offen sc1
  s_add_u32 s58, s35, 98304
  buffer_load_dword v38, v24, s[48:51], s58 offen sc1
  s_add_u32 s58, s35, 114688
  buffer_load_dword v39, v24, s[48:51], s58 offen sc1
  s_waitcnt vmcnt(0)
  v_cmp_eq_u32 vcc, -1, v32
  v_cmp_eq_u32 s[70:71], -1, v33
  s_nop 1
  s_or_b64 vcc, vcc, s[70:71]
  v_cmp_eq_u32 s[70:71], -1, v34
  s_nop 1
  s_or_b64 vcc, vcc, s[70:71]
  v_cmp_eq_u32 s[70:71], -1, v35
  s_nop 1
  s_or_b64 vcc, vcc, s[70:71]
  v_cmp_eq_u32 s[70:71], -1, v36
  s_nop 1
  s_or_b64 vcc, vcc, s[70:71]
  v_cmp_eq_u32 s[70:71], -1, v37
  s_nop 1
  s_or_b64 vcc, vcc, s[70:71]
  v_cmp_eq_u32 s[70:71], -1, v38
  s_nop 1
  s_or_b64 vcc, vcc, s[70:71]
  v_cmp_eq_u32 s[70:71], -1, v39
  s_nop 1
  s_or_b64 vcc, vcc, s[70:71]
  s_cbranch_vccz L_y_ok
  s_sleep 2
  s_sub_u32 s63, s63, 1
  s_cmp_gt_i32 s63, 0
  s_cbranch_scc1 L_y_spin
L_y_ok:
  v_add_f32 v32, v32, v33
  v_add_f32 v32, v32, v34
  v_add_f32 v32, v32, v35
  v_add_f32 v32, v32, v36
  v_add_f32 v32, v32, v37
  v_add_f32 v32, v32, v38
  v_add_f32 v32, v32, v39
  s_nop 1
  v_add_f32_dpp v32, v32, v32 row_ror:8 row_mask:0xf bank_mask:0xf
  v_mov_b32 v33, v32
  s_nop 1
  v_permlane16_swap_b32 v32, v33
  s_nop 0
  v_add_f32 v32, v32, v33
  v_mov_b32 v33, v32
  s_nop 1
  v_permlane32_swap_b32 v32, v33
  s_nop 0
  v_add_f32 v32, v32, v33
  v_cvt_pk_bf16_f32 v32, v32, v32
  s_lshl_b32 s35, s30, 10
  s_lshl_b32 s14, s33, 4
  s_add_u32 s35, s35, s14
  v_lshl_add_u32 v24, v0, 1, s35
  v_cmp_gt_u32 vcc, 8, v0
  s_and_saveexec_b64 s[70:71], vcc
  global_store_short v24, v32, s[24:25]
  s_mov_b64 exec, s[70:71]
L_fin:
L_end:
  s_endpgm
.section .rodata,"a"
.p2align 6
.amdhsa_kernel gated_mix__mha_block_cached__geglu_ffn__decode_kernel
  .amdhsa_next_free_vgpr 168
  .amdhsa_next_free_sgpr 96
  .amdhsa_accum_offset 168
  .amdhsa_group_segment_fixed_size 0
  .amdhsa_kernarg_size 104
  .amdhsa_user_sgpr_count 2
  .amdhsa_user_sgpr_kernarg_segment_ptr 1
  .amdhsa_system_sgpr_workgroup_id_x 1
  .amdhsa_float_denorm_mode_32 3
.end_amdhsa_kernel
```
